```python
import torch

def _softmax(x, axis=-1):
    return torch.softmax(x, dim=axis)
def _gelu(x):
    return torch.nn.functional.gelu(x, approximate="tanh")
def _silu(x):
    return torch.nn.functional.silu(x)
def _sigmoid(x):
    return torch.sigmoid(x)
def _layernorm(x, axis=-1, eps=1e-5):
    m = x.mean(dim=axis, keepdim=True)
    v = x.var(dim=axis, keepdim=True, unbiased=False)
    return (x - m) / torch.sqrt(v + eps)
def _scatter_add(tgt, idx, src, axis=0):
    return tgt.clone().index_add_(axis, idx, src)
def _segment_sum(src, seg, n):
    out = torch.zeros((n,) + src.shape[1:], dtype=src.dtype)
    return out.index_add_(0, seg, src)
def _pad(x, pw):
    flat = tuple(v for pair in reversed(pw) for v in pair)
    return torch.nn.functional.pad(x, flat)

kernel_name = 'standalone__mha_block_cached__near_ridge'

def setup_inputs():

    _w = (lambda a: (lambda t: t.to(torch.bfloat16) if t.is_floating_point() else t)(torch.as_tensor(a)))
    B, Sq, D = 8, 128, 512
    H, Sk, Dh = 32, 2048, 128
    return {
        "x": _w((lambda *s: torch.randn(*s, dtype=torch.bfloat16) * 0.8)(B, Sq, D)),
        "k_cache": _w((lambda *s: torch.randn(*s, dtype=torch.bfloat16) * 0.8)(B, H, Sk, Dh)),
        "v_cache": _w((lambda *s: torch.randn(*s, dtype=torch.bfloat16) * 0.05)(B, H, Sk, Dh)),
        "wq": _w((lambda *s: torch.randn(*s, dtype=torch.bfloat16) * 0.8)(D, H * Dh) * (D ** -0.5)),
        "wo": _w((lambda *s: torch.randn(*s, dtype=torch.bfloat16) * 0.05)(H * Dh, D) * ((H * Dh) ** -0.5)),
    }

def reference(x, k_cache, v_cache, wq, wo):
    B, Sq, D = x.shape
    H, Dh = 32, 128
    q = (lambda x, *d: x.permute(*d))((x @ wq).reshape(B, Sq, H, Dh), 0, 2, 1, 3)
    scores = torch.einsum("bhqd,bhkd->bhqk", q, k_cache) * (Dh ** -0.5)
    p = _softmax(scores, axis=-1)
    o = torch.einsum("bhqk,bhkd->bhqd", p, v_cache)
    return (lambda x, *d: x.permute(*d))(o, 0, 2, 1, 3).reshape(B, Sq, H * Dh) @ wo
```

```asm
; @launch grid=(256,1,1) block=(512,1,1) lds=163840
.amdgcn_target "amdgcn-amd-amdhsa--gfx950"
.text
.globl standalone__mha_block_cached__near_ridge_kernel
.p2align 8
.type standalone__mha_block_cached__near_ridge_kernel,@function
standalone__mha_block_cached__near_ridge_kernel:
    s_cmp_ge_u32 s2, 256
    s_cbranch_scc1 L_end
    s_load_dwordx16 s[4:19], s[0:1], 0
    v_lshrrev_b32 v2, 6, v0
    v_and_b32 v1, 63, v0
    v_readfirstlane_b32 s52, v2
    s_and_b32 s64, s2, 7
    s_lshr_b32 s65, s2, 3
    s_and_b32 s66, s65, 3
    s_lshr_b32 s67, s65, 2
    s_and_b32 s56, s64, 7
    s_lshl_b32 s56, s56, 2
    s_add_u32 s56, s56, s66
    s_lshr_b32 s55, s64, 3
    s_lshl_b32 s55, s55, 3
    s_add_u32 s55, s55, s67
    s_mul_i32 s73, s67, 1
    s_mul_i32 s66, s66, 2
    s_add_u32 s73, s73, s66
    s_and_b32 s70, s65, 3
    s_lshr_b32 s66, s65, 2
    s_and_b32 s71, s66, 3
    s_lshr_b32 s66, s66, 2
    s_and_b32 s69, s64, 3
    s_lshl_b32 s69, s69, 1
    s_add_u32 s69, s69, s66
    s_lshr_b32 s67, s64, 2
    s_lshl_b32 s67, s67, 2
    s_add_u32 s71, s71, s67
    s_lshl_b32 s84, s71, 1
    s_add_u32 s84, s84, s70
    s_lshl_b32 s66, s69, 2
    s_add_u32 s84, s84, s66
    s_and_b32 s84, s84, 7
    s_lshl_b32 s84, s84, 1
    s_and_b32 s53, s52, 3
    s_lshr_b32 s54, s52, 2
    s_lshl_b32 s68, s52, 11
    s_lshl_b32 s78, s52, 12
    s_mov_b32 s57, 0x3e0293ee
    s_mov_b32 s58, 0xbe0293ee
    v_lshrrev_b32 v240, 4, v1
    v_and_b32 v241, 15, v1
    v_lshrrev_b32 v242, 3, v1
    v_and_b32 v243, 7, v1
    s_and_b32 s64, s52, 1
    s_lshl_b32 s64, s64, 3
    v_lshlrev_b32 v246, 1, v240
    v_or_b32 v246, s64, v246
    v_xor_b32 v246, v246, v241
    v_lshlrev_b32 v246, 4, v246
    v_lshl_add_u32 v14, v240, 13, v246
    s_lshl_b32 s64, s52, 16
    v_add_u32 v14, s64, v14
    v_add_u32 v15, 31744, v14
    v_lshrrev_b32 v246, 1, v242
    v_xor_b32 v246, v246, v243
    v_lshlrev_b32 v246, 4, v246
    v_lshl_add_u32 v12, v242, 10, v246
    s_lshl_b32 s64, s52, 14
    v_add_u32 v12, s64, v12
    v_xor_b32 v13, 64, v12
    v_add_u32 v13, 7168, v13
    s_waitcnt lgkmcnt(0)
    s_lshl_b32 s65, s56, 8
    s_add_u32 s28, s10, s65
    s_addc_u32 s29, s11, 0
    s_mov_b32 s30, 0x3fe100
    s_mov_b32 s31, 0x20000
    s_lshl_b32 s65, s55, 17
    s_add_u32 s32, s4, s65
    s_addc_u32 s33, s5, 0
    s_mov_b32 s34, 0x20000
    s_mov_b32 s35, 0x20000
    s_add_u32 s66, s73, 0
    s_and_b32 s66, s66, 7
    s_add_u32 s67, s68, 32768
    s_mov_b32 m0, s67
    s_lshl_b32 s65, s66, 19
    s_lshl_b32 s66, s66, 7
    buffer_load_dwordx4 v12, s[32:35], s66 offen lds
    buffer_load_dwordx4 v13, s[32:35], s66 offen offset:1024 lds
    s_add_u32 s67, s67, 16384
    s_mov_b32 m0, s67
    s_nop 0
    buffer_load_dwordx4 v14, s[28:31], s65 offen lds
    buffer_load_dwordx4 v15, s[28:31], s65 offen offset:1024 lds
    s_add_u32 s66, s73, 1
    s_and_b32 s66, s66, 7
    s_add_u32 s67, s68, 65536
    s_mov_b32 m0, s67
    s_lshl_b32 s65, s66, 19
    s_lshl_b32 s66, s66, 7
    buffer_load_dwordx4 v12, s[32:35], s66 offen lds
    buffer_load_dwordx4 v13, s[32:35], s66 offen offset:1024 lds
    s_add_u32 s67, s67, 16384
    s_mov_b32 m0, s67
    s_nop 0
    buffer_load_dwordx4 v14, s[28:31], s65 offen lds
    buffer_load_dwordx4 v15, s[28:31], s65 offen offset:1024 lds
    s_lshl_b32 s64, s52, 3
    s_and_b32 s64, s64, 8
    v_add_u32 v246, s64, v240
    v_xor_b32 v246, v246, v241
    v_lshlrev_b32 v246, 4, v246
    v_lshl_add_u32 v2, v240, 8, v246
    v_add_u32 v2, s68, v2
    v_xor_b32 v3, 64, v2
    v_lshlrev_b32 v246, 1, v240
    v_xor_b32 v247, v246, v241
    v_lshlrev_b32 v247, 4, v247
    v_lshl_add_u32 v4, v240, 8, v247
    v_add_u32 v4, s68, v4
    v_xor_b32 v5, 128, v4
    v_xor_b32 v247, v246, v243
    v_lshlrev_b32 v247, 4, v247
    v_lshl_add_u32 v236, v242, 10, v247
    v_add_u32 v237, 7168, v236
    v_add_u32 v238, 14336, v236
    v_add_u32 v239, 21504, v236
    s_lshl_b32 s64, s55, 5
    s_add_u32 s64, s64, s56
    s_lshl_b32 s65, s64, 19
    s_add_u32 s20, s6, s65
    s_addc_u32 s21, s7, 0
    s_mov_b32 s22, 0x80000
    s_mov_b32 s23, 0x20000
    s_add_u32 s24, s8, s65
    s_addc_u32 s25, s9, 0
    s_mov_b32 s26, 0x80000
    s_mov_b32 s27, 0x20000
    s_mov_b32 s59, 0
    s_mov_b32 s60, 0
    s_lshl_b32 s65, s55, 21
    s_lshl_b32 s64, s56, 13
    s_add_u32 s65, s65, s64
    s_add_u32 s36, s18, s65
    s_addc_u32 s37, s19, 0
    s_mov_b32 s38, 0xc2000
    s_mov_b32 s39, 0x20000
    s_lshl_b32 s65, s69, 21
    s_lshl_b32 s64, s70, 18
    s_add_u32 s65, s65, s64
    s_lshl_b32 s64, s52, 15
    s_add_u32 s65, s65, s64
    s_add_u32 s80, s18, s65
    s_addc_u32 s81, s19, 0
    s_mov_b32 s82, 0x8000
    s_mov_b32 s83, 0x20000
    s_lshl_b32 s64, s52, 19
    s_lshl_b32 s65, s71, 7
    s_add_u32 s64, s64, s65
    s_add_u32 s40, s12, s64
    s_addc_u32 s41, s13, 0
    s_mov_b32 s42, 0x7fc80
    s_mov_b32 s43, 0x20000
    s_lshl_b32 s64, s69, 17
    s_lshl_b32 s65, s70, 15
    s_add_u32 s64, s64, s65
    s_lshl_b32 s65, s71, 7
    s_add_u32 s64, s64, s65
    s_add_u32 s44, s14, s64
    s_addc_u32 s45, s15, 0
    s_mov_b32 s46, 0x7c80
    s_mov_b32 s47, 0x20000
    s_mov_b32 s48, s16
    s_mov_b32 s49, s17
    s_mov_b32 s50, 256
    s_mov_b32 s51, 0x20000
    s_add_u32 s66, s73, 2
    s_and_b32 s66, s66, 7
    s_add_u32 s67, s68, 98304
    s_mov_b32 m0, s67
    s_lshl_b32 s65, s66, 19
    s_lshl_b32 s66, s66, 7
    buffer_load_dwordx4 v12, s[32:35], s66 offen lds
    buffer_load_dwordx4 v13, s[32:35], s66 offen offset:1024 lds
    s_add_u32 s67, s67, 16384
    s_mov_b32 m0, s67
    s_nop 0
    buffer_load_dwordx4 v14, s[28:31], s65 offen lds
    buffer_load_dwordx4 v15, s[28:31], s65 offen offset:1024 lds
    s_add_u32 s66, s73, 3
    s_and_b32 s66, s66, 7
    s_add_u32 s67, s68, 131072
    s_mov_b32 m0, s67
    s_lshl_b32 s65, s66, 19
    s_lshl_b32 s66, s66, 7
    buffer_load_dwordx4 v12, s[32:35], s66 offen lds
    buffer_load_dwordx4 v13, s[32:35], s66 offen offset:1024 lds
    s_add_u32 s67, s67, 16384
    s_mov_b32 m0, s67
    s_nop 0
    buffer_load_dwordx4 v14, s[28:31], s65 offen lds
    buffer_load_dwordx4 v15, s[28:31], s65 offen offset:1024 lds
    s_add_u32 s64, s68, 0
    s_mov_b32 m0, s64
    s_nop 0
    buffer_load_dwordx4 v2, s[20:23], s59 offen nt lds
    buffer_load_dwordx4 v3, s[20:23], s59 offen offset:1024 nt lds
    s_add_u32 s59, s59, 16384
    s_add_u32 s64, s68, 16384
    s_mov_b32 m0, s64
    s_nop 0
    buffer_load_dwordx4 v2, s[20:23], s59 offen nt lds
    buffer_load_dwordx4 v3, s[20:23], s59 offen offset:1024 nt lds
    s_add_u32 s59, s59, 16384
    buffer_load_dword v232, v4, s[24:27], 0 offen nt
    v_bfe_u32 v244, v1, 2, 2
    v_and_b32 v245, 3, v1
    v_lshlrev_b32 v245, 3, v245
    s_lshl_b32 s65, s54, 7
    v_and_b32 v243, 1, v240
    v_lshl_add_u32 v243, v243, 2, v244
    v_lshl_add_u32 v246, v243, 5, v245
    v_xor_b32 v246, s65, v246
    v_lshl_add_u32 v247, v240, 3, v244
    v_lshl_add_u32 v247, v247, 8, v246
    v_add_u32 v247, 16384, v247
    v_xor_b32 v26, 0, v247
    v_xor_b32 v27, 32, v247
    v_xor_b32 v28, 64, v247
    v_xor_b32 v29, 96, v247
    v_lshl_add_u32 v247, v240, 2, v244
    v_lshl_add_u32 v247, v247, 8, v246
    s_lshl_b32 s64, s54, 13
    s_add_u32 s66, s64, 49152
    v_add_u32 v247, s66, v247
    v_xor_b32 v16, 0, v247
    v_xor_b32 v17, 32, v247
    v_xor_b32 v18, 64, v247
    v_xor_b32 v19, 96, v247
    v_xor_b32 v20, 128, v247
    v_xor_b32 v21, 160, v247
    v_xor_b32 v22, 192, v247
    v_xor_b32 v23, 224, v247
    v_lshrrev_b32 v246, 1, v241
    v_xor_b32 v246, v246, v240
    v_lshlrev_b32 v246, 4, v246
    v_lshl_add_u32 v246, v241, 7, v246
    s_lshl_b32 s66, s53, 12
    v_add_u32 v24, s66, v246
    v_xor_b32 v25, 64, v24
    v_xor_b32 v242, v240, v241
    v_lshlrev_b32 v242, 4, v242
    v_lshl_add_u32 v242, v241, 8, v242
    v_add_u32 v246, s64, v242
    v_xor_b32 v8, 0, v246
    v_xor_b32 v9, 64, v246
    v_xor_b32 v10, 128, v246
    v_xor_b32 v11, 192, v246
    s_waitcnt vmcnt(17) lgkmcnt(0)
    s_barrier
    ds_read_b128 v[96:99], v24 offset:32768
    ds_read_b128 v[100:103], v24 offset:34816
    ds_read_b64_tr_b16 v[104:105], v26 offset:32768
    ds_read_b64_tr_b16 v[106:107], v26 offset:33792
    ds_read_b64_tr_b16 v[108:109], v27 offset:32768
    ds_read_b64_tr_b16 v[110:111], v27 offset:33792
    ds_read_b64_tr_b16 v[112:113], v28 offset:32768
    ds_read_b64_tr_b16 v[114:115], v28 offset:33792
    s_waitcnt lgkmcnt(4)
    v_mfma_f32_16x16x32_bf16 v[64:67], v[104:107], v[96:99], 0
    ds_read_b64_tr_b16 v[116:117], v29 offset:32768
    v_mfma_f32_16x16x32_bf16 v[68:71], v[104:107], v[100:103], 0
    ds_read_b64_tr_b16 v[118:119], v29 offset:33792
    ds_read_b128 v[120:123], v25 offset:32768
    s_waitcnt lgkmcnt(5)
    v_mfma_f32_16x16x32_bf16 v[72:75], v[108:111], v[96:99], 0
    ds_read_b128 v[124:127], v25 offset:34816
    v_mfma_f32_16x16x32_bf16 v[76:79], v[108:111], v[100:103], 0
    ds_read_b64_tr_b16 v[128:129], v26 offset:40960
    ds_read_b64_tr_b16 v[130:131], v26 offset:41984
    s_waitcnt lgkmcnt(6)
    v_mfma_f32_16x16x32_bf16 v[80:83], v[112:115], v[96:99], 0
    ds_read_b64_tr_b16 v[132:133], v27 offset:40960
    v_mfma_f32_16x16x32_bf16 v[84:87], v[112:115], v[100:103], 0
    ds_read_b64_tr_b16 v[134:135], v27 offset:41984
    ds_read_b64_tr_b16 v[136:137], v28 offset:40960
    s_waitcnt lgkmcnt(7)
    v_mfma_f32_16x16x32_bf16 v[88:91], v[116:119], v[96:99], 0
    ds_read_b64_tr_b16 v[138:139], v28 offset:41984
    v_mfma_f32_16x16x32_bf16 v[92:95], v[116:119], v[100:103], 0
    ds_read_b64_tr_b16 v[140:141], v29 offset:40960
    ds_read_b64_tr_b16 v[142:143], v29 offset:41984
    s_waitcnt lgkmcnt(6)
    v_mfma_f32_16x16x32_bf16 v[64:67], v[128:131], v[120:123], v[64:67]
    v_mfma_f32_16x16x32_bf16 v[68:71], v[128:131], v[124:127], v[68:71]
    s_waitcnt lgkmcnt(4)
    v_mfma_f32_16x16x32_bf16 v[72:75], v[132:135], v[120:123], v[72:75]
    v_mfma_f32_16x16x32_bf16 v[76:79], v[132:135], v[124:127], v[76:79]
    s_waitcnt lgkmcnt(2)
    v_mfma_f32_16x16x32_bf16 v[80:83], v[136:139], v[120:123], v[80:83]
    v_mfma_f32_16x16x32_bf16 v[84:87], v[136:139], v[124:127], v[84:87]
    s_waitcnt lgkmcnt(0)
    v_mfma_f32_16x16x32_bf16 v[88:91], v[140:143], v[120:123], v[88:91]
    v_mfma_f32_16x16x32_bf16 v[92:95], v[140:143], v[124:127], v[92:95]
    s_mov_b32 s64, 65536
    v_add_u32 v24, s64, v24
    v_add_u32 v25, s64, v25
    v_add_u32 v26, s64, v26
    v_add_u32 v27, s64, v27
    v_add_u32 v28, s64, v28
    v_add_u32 v29, s64, v29
    s_waitcnt vmcnt(13) lgkmcnt(0)
    s_barrier
    ds_read_b128 v[144:147], v24 offset:0
    ds_read_b128 v[148:151], v24 offset:2048
    ds_read_b64_tr_b16 v[152:153], v26 offset:0
    ds_read_b64_tr_b16 v[154:155], v26 offset:1024
    ds_read_b64_tr_b16 v[156:157], v27 offset:0
    ds_read_b64_tr_b16 v[158:159], v27 offset:1024
    ds_read_b64_tr_b16 v[160:161], v28 offset:0
    ds_read_b64_tr_b16 v[162:163], v28 offset:1024
    s_waitcnt lgkmcnt(4)
    v_mfma_f32_16x16x32_bf16 v[64:67], v[152:155], v[144:147], v[64:67]
    ds_read_b64_tr_b16 v[164:165], v29 offset:0
    v_mfma_f32_16x16x32_bf16 v[68:71], v[152:155], v[148:151], v[68:71]
    ds_read_b64_tr_b16 v[166:167], v29 offset:1024
    ds_read_b128 v[168:171], v25 offset:0
    s_add_u32 s66, s73, 4
    s_and_b32 s66, s66, 7
    s_add_u32 s67, s68, 32768
    s_mov_b32 m0, s67
    s_lshl_b32 s65, s66, 19
    s_lshl_b32 s66, s66, 7
    buffer_load_dwordx4 v12, s[32:35], s66 offen lds
    s_waitcnt lgkmcnt(5)
    v_mfma_f32_16x16x32_bf16 v[72:75], v[156:159], v[144:147], v[72:75]
    ds_read_b128 v[172:175], v25 offset:2048
    v_mfma_f32_16x16x32_bf16 v[76:79], v[156:159], v[148:151], v[76:79]
    ds_read_b64_tr_b16 v[176:177], v26 offset:8192
    ds_read_b64_tr_b16 v[178:179], v26 offset:9216
    buffer_load_dwordx4 v13, s[32:35], s66 offen offset:1024 lds
    s_waitcnt lgkmcnt(6)
    v_mfma_f32_16x16x32_bf16 v[80:83], v[160:163], v[144:147], v[80:83]
    ds_read_b64_tr_b16 v[180:181], v27 offset:8192
    v_mfma_f32_16x16x32_bf16 v[84:87], v[160:163], v[148:151], v[84:87]
    ds_read_b64_tr_b16 v[182:183], v27 offset:9216
    ds_read_b64_tr_b16 v[184:185], v28 offset:8192
    s_add_u32 s67, s67, 16384
    s_mov_b32 m0, s67
    s_nop 0
    buffer_load_dwordx4 v14, s[28:31], s65 offen lds
    s_waitcnt lgkmcnt(7)
    v_mfma_f32_16x16x32_bf16 v[88:91], v[164:167], v[144:147], v[88:91]
    ds_read_b64_tr_b16 v[186:187], v28 offset:9216
    v_mfma_f32_16x16x32_bf16 v[92:95], v[164:167], v[148:151], v[92:95]
    ds_read_b64_tr_b16 v[188:189], v29 offset:8192
    ds_read_b64_tr_b16 v[190:191], v29 offset:9216
    buffer_load_dwordx4 v15, s[28:31], s65 offen offset:1024 lds
    s_waitcnt lgkmcnt(6)
    v_mfma_f32_16x16x32_bf16 v[64:67], v[176:179], v[168:171], v[64:67]
    v_mfma_f32_16x16x32_bf16 v[68:71], v[176:179], v[172:175], v[68:71]
    s_waitcnt lgkmcnt(4)
    v_mfma_f32_16x16x32_bf16 v[72:75], v[180:183], v[168:171], v[72:75]
    v_mfma_f32_16x16x32_bf16 v[76:79], v[180:183], v[172:175], v[76:79]
    s_waitcnt lgkmcnt(2)
    v_mfma_f32_16x16x32_bf16 v[80:83], v[184:187], v[168:171], v[80:83]
    v_mfma_f32_16x16x32_bf16 v[84:87], v[184:187], v[172:175], v[84:87]
    s_waitcnt lgkmcnt(0)
    v_mfma_f32_16x16x32_bf16 v[88:91], v[188:191], v[168:171], v[88:91]
    v_mfma_f32_16x16x32_bf16 v[92:95], v[188:191], v[172:175], v[92:95]
    s_waitcnt vmcnt(13) lgkmcnt(0)
    s_barrier
    ds_read_b128 v[96:99], v24 offset:32768
    ds_read_b128 v[100:103], v24 offset:34816
    ds_read_b64_tr_b16 v[104:105], v26 offset:32768
    ds_read_b64_tr_b16 v[106:107], v26 offset:33792
    ds_read_b64_tr_b16 v[108:109], v27 offset:32768
    ds_read_b64_tr_b16 v[110:111], v27 offset:33792
    ds_read_b64_tr_b16 v[112:113], v28 offset:32768
    ds_read_b64_tr_b16 v[114:115], v28 offset:33792
    s_waitcnt lgkmcnt(4)
    v_mfma_f32_16x16x32_bf16 v[64:67], v[104:107], v[96:99], v[64:67]
    ds_read_b64_tr_b16 v[116:117], v29 offset:32768
    v_mfma_f32_16x16x32_bf16 v[68:71], v[104:107], v[100:103], v[68:71]
    ds_read_b64_tr_b16 v[118:119], v29 offset:33792
    ds_read_b128 v[120:123], v25 offset:32768
    s_add_u32 s66, s73, 5
    s_and_b32 s66, s66, 7
    s_add_u32 s67, s68, 65536
    s_mov_b32 m0, s67
    s_lshl_b32 s65, s66, 19
    s_lshl_b32 s66, s66, 7
    buffer_load_dwordx4 v12, s[32:35], s66 offen lds
    s_waitcnt lgkmcnt(5)
    v_mfma_f32_16x16x32_bf16 v[72:75], v[108:111], v[96:99], v[72:75]
    ds_read_b128 v[124:127], v25 offset:34816
    v_mfma_f32_16x16x32_bf16 v[76:79], v[108:111], v[100:103], v[76:79]
    ds_read_b64_tr_b16 v[128:129], v26 offset:40960
    ds_read_b64_tr_b16 v[130:131], v26 offset:41984
    buffer_load_dwordx4 v13, s[32:35], s66 offen offset:1024 lds
    s_waitcnt lgkmcnt(6)
    v_mfma_f32_16x16x32_bf16 v[80:83], v[112:115], v[96:99], v[80:83]
    ds_read_b64_tr_b16 v[132:133], v27 offset:40960
    v_mfma_f32_16x16x32_bf16 v[84:87], v[112:115], v[100:103], v[84:87]
    ds_read_b64_tr_b16 v[134:135], v27 offset:41984
    ds_read_b64_tr_b16 v[136:137], v28 offset:40960
    s_add_u32 s67, s67, 16384
    s_mov_b32 m0, s67
    s_nop 0
    buffer_load_dwordx4 v14, s[28:31], s65 offen lds
    s_waitcnt lgkmcnt(7)
    v_mfma_f32_16x16x32_bf16 v[88:91], v[116:119], v[96:99], v[88:91]
    ds_read_b64_tr_b16 v[138:139], v28 offset:41984
    v_mfma_f32_16x16x32_bf16 v[92:95], v[116:119], v[100:103], v[92:95]
    ds_read_b64_tr_b16 v[140:141], v29 offset:40960
    ds_read_b64_tr_b16 v[142:143], v29 offset:41984
    buffer_load_dwordx4 v15, s[28:31], s65 offen offset:1024 lds
    s_waitcnt lgkmcnt(6)
    v_mfma_f32_16x16x32_bf16 v[64:67], v[128:131], v[120:123], v[64:67]
    v_mfma_f32_16x16x32_bf16 v[68:71], v[128:131], v[124:127], v[68:71]
    s_waitcnt lgkmcnt(4)
    v_mfma_f32_16x16x32_bf16 v[72:75], v[132:135], v[120:123], v[72:75]
    v_mfma_f32_16x16x32_bf16 v[76:79], v[132:135], v[124:127], v[76:79]
    s_waitcnt lgkmcnt(2)
    v_mfma_f32_16x16x32_bf16 v[80:83], v[136:139], v[120:123], v[80:83]
    v_mfma_f32_16x16x32_bf16 v[84:87], v[136:139], v[124:127], v[84:87]
    s_waitcnt lgkmcnt(0)
    v_mfma_f32_16x16x32_bf16 v[88:91], v[140:143], v[120:123], v[88:91]
    v_mfma_f32_16x16x32_bf16 v[92:95], v[140:143], v[124:127], v[92:95]
    s_mov_b32 s64, 65536
    v_add_u32 v24, s64, v24
    v_add_u32 v25, s64, v25
    v_add_u32 v26, s64, v26
    v_add_u32 v27, s64, v27
    v_add_u32 v28, s64, v28
    v_add_u32 v29, s64, v29
    s_waitcnt vmcnt(13) lgkmcnt(0)
    s_barrier
    ds_read_b128 v[144:147], v24 offset:0
    ds_read_b128 v[148:151], v24 offset:2048
    ds_read_b64_tr_b16 v[152:153], v26 offset:0
    ds_read_b64_tr_b16 v[154:155], v26 offset:1024
    ds_read_b64_tr_b16 v[156:157], v27 offset:0
    ds_read_b64_tr_b16 v[158:159], v27 offset:1024
    ds_read_b64_tr_b16 v[160:161], v28 offset:0
    ds_read_b64_tr_b16 v[162:163], v28 offset:1024
    s_waitcnt lgkmcnt(4)
    v_mfma_f32_16x16x32_bf16 v[64:67], v[152:155], v[144:147], v[64:67]
    ds_read_b64_tr_b16 v[164:165], v29 offset:0
    v_mfma_f32_16x16x32_bf16 v[68:71], v[152:155], v[148:151], v[68:71]
    ds_read_b64_tr_b16 v[166:167], v29 offset:1024
    ds_read_b128 v[168:171], v25 offset:0
    s_add_u32 s66, s73, 6
    s_and_b32 s66, s66, 7
    s_add_u32 s67, s68, 98304
    s_mov_b32 m0, s67
    s_lshl_b32 s65, s66, 19
    s_lshl_b32 s66, s66, 7
    buffer_load_dwordx4 v12, s[32:35], s66 offen lds
    s_waitcnt lgkmcnt(5)
    v_mfma_f32_16x16x32_bf16 v[72:75], v[156:159], v[144:147], v[72:75]
    ds_read_b128 v[172:175], v25 offset:2048
    v_mfma_f32_16x16x32_bf16 v[76:79], v[156:159], v[148:151], v[76:79]
    ds_read_b64_tr_b16 v[176:177], v26 offset:8192
    ds_read_b64_tr_b16 v[178:179], v26 offset:9216
    buffer_load_dwordx4 v13, s[32:35], s66 offen offset:1024 lds
    s_waitcnt lgkmcnt(6)
    v_mfma_f32_16x16x32_bf16 v[80:83], v[160:163], v[144:147], v[80:83]
    ds_read_b64_tr_b16 v[180:181], v27 offset:8192
    v_mfma_f32_16x16x32_bf16 v[84:87], v[160:163], v[148:151], v[84:87]
    ds_read_b64_tr_b16 v[182:183], v27 offset:9216
    ds_read_b64_tr_b16 v[184:185], v28 offset:8192
    s_add_u32 s67, s67, 16384
    s_mov_b32 m0, s67
    s_nop 0
    buffer_load_dwordx4 v14, s[28:31], s65 offen lds
    s_waitcnt lgkmcnt(7)
    v_mfma_f32_16x16x32_bf16 v[88:91], v[164:167], v[144:147], v[88:91]
    ds_read_b64_tr_b16 v[186:187], v28 offset:9216
    v_mfma_f32_16x16x32_bf16 v[92:95], v[164:167], v[148:151], v[92:95]
    ds_read_b64_tr_b16 v[188:189], v29 offset:8192
    ds_read_b64_tr_b16 v[190:191], v29 offset:9216
    buffer_load_dwordx4 v15, s[28:31], s65 offen offset:1024 lds
    s_waitcnt lgkmcnt(6)
    v_mfma_f32_16x16x32_bf16 v[64:67], v[176:179], v[168:171], v[64:67]
    v_mfma_f32_16x16x32_bf16 v[68:71], v[176:179], v[172:175], v[68:71]
    s_waitcnt lgkmcnt(4)
    v_mfma_f32_16x16x32_bf16 v[72:75], v[180:183], v[168:171], v[72:75]
    v_mfma_f32_16x16x32_bf16 v[76:79], v[180:183], v[172:175], v[76:79]
    s_waitcnt lgkmcnt(2)
    v_mfma_f32_16x16x32_bf16 v[80:83], v[184:187], v[168:171], v[80:83]
    v_mfma_f32_16x16x32_bf16 v[84:87], v[184:187], v[172:175], v[84:87]
    s_waitcnt lgkmcnt(0)
    v_mfma_f32_16x16x32_bf16 v[88:91], v[188:191], v[168:171], v[88:91]
    v_mfma_f32_16x16x32_bf16 v[92:95], v[188:191], v[172:175], v[92:95]
    s_mov_b32 s64, -131072
    v_add_u32 v24, s64, v24
    v_add_u32 v25, s64, v25
    v_add_u32 v26, s64, v26
    v_add_u32 v27, s64, v27
    v_add_u32 v28, s64, v28
    v_add_u32 v29, s64, v29
    s_waitcnt vmcnt(8) lgkmcnt(0)
    s_barrier
    ds_read_b128 v[96:99], v24 offset:32768
    ds_read_b128 v[100:103], v24 offset:34816
    ds_read_b64_tr_b16 v[104:105], v26 offset:32768
    ds_read_b64_tr_b16 v[106:107], v26 offset:33792
    ds_read_b64_tr_b16 v[108:109], v27 offset:32768
    ds_read_b64_tr_b16 v[110:111], v27 offset:33792
    ds_read_b64_tr_b16 v[112:113], v28 offset:32768
    ds_read_b64_tr_b16 v[114:115], v28 offset:33792
    s_waitcnt lgkmcnt(4)
    v_mfma_f32_16x16x32_bf16 v[64:67], v[104:107], v[96:99], v[64:67]
    ds_read_b64_tr_b16 v[116:117], v29 offset:32768
    v_mfma_f32_16x16x32_bf16 v[68:71], v[104:107], v[100:103], v[68:71]
    ds_read_b64_tr_b16 v[118:119], v29 offset:33792
    ds_read_b128 v[120:123], v25 offset:32768
    s_add_u32 s66, s73, 7
    s_and_b32 s66, s66, 7
    s_add_u32 s67, s68, 131072
    s_mov_b32 m0, s67
    s_lshl_b32 s65, s66, 19
    s_lshl_b32 s66, s66, 7
    buffer_load_dwordx4 v12, s[32:35], s66 offen lds
    s_waitcnt lgkmcnt(5)
    v_mfma_f32_16x16x32_bf16 v[72:75], v[108:111], v[96:99], v[72:75]
    ds_read_b128 v[124:127], v25 offset:34816
    v_mfma_f32_16x16x32_bf16 v[76:79], v[108:111], v[100:103], v[76:79]
    ds_read_b64_tr_b16 v[128:129], v26 offset:40960
    ds_read_b64_tr_b16 v[130:131], v26 offset:41984
    buffer_load_dwordx4 v13, s[32:35], s66 offen offset:1024 lds
    s_waitcnt lgkmcnt(6)
    v_mfma_f32_16x16x32_bf16 v[80:83], v[112:115], v[96:99], v[80:83]
    ds_read_b64_tr_b16 v[132:133], v27 offset:40960
    v_mfma_f32_16x16x32_bf16 v[84:87], v[112:115], v[100:103], v[84:87]
    ds_read_b64_tr_b16 v[134:135], v27 offset:41984
    ds_read_b64_tr_b16 v[136:137], v28 offset:40960
    s_add_u32 s67, s67, 16384
    s_mov_b32 m0, s67
    s_nop 0
    buffer_load_dwordx4 v14, s[28:31], s65 offen lds
    s_waitcnt lgkmcnt(7)
    v_mfma_f32_16x16x32_bf16 v[88:91], v[116:119], v[96:99], v[88:91]
    ds_read_b64_tr_b16 v[138:139], v28 offset:41984
    v_mfma_f32_16x16x32_bf16 v[92:95], v[116:119], v[100:103], v[92:95]
    ds_read_b64_tr_b16 v[140:141], v29 offset:40960
    ds_read_b64_tr_b16 v[142:143], v29 offset:41984
    buffer_load_dwordx4 v15, s[28:31], s65 offen offset:1024 lds
    s_waitcnt lgkmcnt(6)
    v_mfma_f32_16x16x32_bf16 v[64:67], v[128:131], v[120:123], v[64:67]
    v_mfma_f32_16x16x32_bf16 v[68:71], v[128:131], v[124:127], v[68:71]
    s_waitcnt lgkmcnt(4)
    v_mfma_f32_16x16x32_bf16 v[72:75], v[132:135], v[120:123], v[72:75]
    v_mfma_f32_16x16x32_bf16 v[76:79], v[132:135], v[124:127], v[76:79]
    s_waitcnt lgkmcnt(2)
    v_mfma_f32_16x16x32_bf16 v[80:83], v[136:139], v[120:123], v[80:83]
    v_mfma_f32_16x16x32_bf16 v[84:87], v[136:139], v[124:127], v[84:87]
    s_waitcnt lgkmcnt(0)
    v_mfma_f32_16x16x32_bf16 v[88:91], v[140:143], v[120:123], v[88:91]
    v_mfma_f32_16x16x32_bf16 v[92:95], v[140:143], v[124:127], v[92:95]
    s_mov_b32 s64, 65536
    v_add_u32 v24, s64, v24
    v_add_u32 v25, s64, v25
    v_add_u32 v26, s64, v26
    v_add_u32 v27, s64, v27
    v_add_u32 v28, s64, v28
    v_add_u32 v29, s64, v29
    s_waitcnt vmcnt(8) lgkmcnt(0)
    s_barrier
    ds_read_b128 v[144:147], v24 offset:0
    ds_read_b128 v[148:151], v24 offset:2048
    ds_read_b64_tr_b16 v[152:153], v26 offset:0
    ds_read_b64_tr_b16 v[154:155], v26 offset:1024
    ds_read_b64_tr_b16 v[156:157], v27 offset:0
    ds_read_b64_tr_b16 v[158:159], v27 offset:1024
    ds_read_b64_tr_b16 v[160:161], v28 offset:0
    ds_read_b64_tr_b16 v[162:163], v28 offset:1024
    s_waitcnt lgkmcnt(4)
    v_mfma_f32_16x16x32_bf16 v[64:67], v[152:155], v[144:147], v[64:67]
    ds_read_b64_tr_b16 v[164:165], v29 offset:0
    v_mfma_f32_16x16x32_bf16 v[68:71], v[152:155], v[148:151], v[68:71]
    ds_read_b64_tr_b16 v[166:167], v29 offset:1024
    ds_read_b128 v[168:171], v25 offset:0
    s_waitcnt lgkmcnt(5)
    v_mfma_f32_16x16x32_bf16 v[72:75], v[156:159], v[144:147], v[72:75]
    ds_read_b128 v[172:175], v25 offset:2048
    v_mfma_f32_16x16x32_bf16 v[76:79], v[156:159], v[148:151], v[76:79]
    ds_read_b64_tr_b16 v[176:177], v26 offset:8192
    ds_read_b64_tr_b16 v[178:179], v26 offset:9216
    s_waitcnt lgkmcnt(6)
    v_mfma_f32_16x16x32_bf16 v[80:83], v[160:163], v[144:147], v[80:83]
    ds_read_b64_tr_b16 v[180:181], v27 offset:8192
    v_mfma_f32_16x16x32_bf16 v[84:87], v[160:163], v[148:151], v[84:87]
    ds_read_b64_tr_b16 v[182:183], v27 offset:9216
    ds_read_b64_tr_b16 v[184:185], v28 offset:8192
    s_waitcnt lgkmcnt(7)
    v_mfma_f32_16x16x32_bf16 v[88:91], v[164:167], v[144:147], v[88:91]
    ds_read_b64_tr_b16 v[186:187], v28 offset:9216
    v_mfma_f32_16x16x32_bf16 v[92:95], v[164:167], v[148:151], v[92:95]
    ds_read_b64_tr_b16 v[188:189], v29 offset:8192
    ds_read_b64_tr_b16 v[190:191], v29 offset:9216
    s_waitcnt lgkmcnt(6)
    v_mfma_f32_16x16x32_bf16 v[64:67], v[176:179], v[168:171], v[64:67]
    v_mfma_f32_16x16x32_bf16 v[68:71], v[176:179], v[172:175], v[68:71]
    s_waitcnt lgkmcnt(4)
    v_mfma_f32_16x16x32_bf16 v[72:75], v[180:183], v[168:171], v[72:75]
    v_mfma_f32_16x16x32_bf16 v[76:79], v[180:183], v[172:175], v[76:79]
    s_waitcnt lgkmcnt(2)
    v_mfma_f32_16x16x32_bf16 v[80:83], v[184:187], v[168:171], v[80:83]
    v_mfma_f32_16x16x32_bf16 v[84:87], v[184:187], v[172:175], v[84:87]
    s_waitcnt lgkmcnt(0)
    v_mfma_f32_16x16x32_bf16 v[88:91], v[188:191], v[168:171], v[88:91]
    v_mfma_f32_16x16x32_bf16 v[92:95], v[188:191], v[172:175], v[92:95]
    s_waitcnt vmcnt(4) lgkmcnt(0)
    s_barrier
    ds_read_b128 v[96:99], v24 offset:32768
    ds_read_b128 v[100:103], v24 offset:34816
    ds_read_b64_tr_b16 v[104:105], v26 offset:32768
    ds_read_b64_tr_b16 v[106:107], v26 offset:33792
    ds_read_b64_tr_b16 v[108:109], v27 offset:32768
    ds_read_b64_tr_b16 v[110:111], v27 offset:33792
    ds_read_b64_tr_b16 v[112:113], v28 offset:32768
    ds_read_b64_tr_b16 v[114:115], v28 offset:33792
    s_waitcnt lgkmcnt(4)
    v_mfma_f32_16x16x32_bf16 v[64:67], v[104:107], v[96:99], v[64:67]
    ds_read_b64_tr_b16 v[116:117], v29 offset:32768
    v_mfma_f32_16x16x32_bf16 v[68:71], v[104:107], v[100:103], v[68:71]
    ds_read_b64_tr_b16 v[118:119], v29 offset:33792
    ds_read_b128 v[120:123], v25 offset:32768
    s_add_u32 s64, s68, 32768
    s_mov_b32 m0, s64
    s_nop 0
    buffer_load_dwordx4 v2, s[20:23], s59 offen nt lds
    s_waitcnt lgkmcnt(5)
    v_mfma_f32_16x16x32_bf16 v[72:75], v[108:111], v[96:99], v[72:75]
    ds_read_b128 v[124:127], v25 offset:34816
    v_mfma_f32_16x16x32_bf16 v[76:79], v[108:111], v[100:103], v[76:79]
    ds_read_b64_tr_b16 v[128:129], v26 offset:40960
    ds_read_b64_tr_b16 v[130:131], v26 offset:41984
    buffer_load_dwordx4 v3, s[20:23], s59 offen offset:1024 nt lds
    s_add_u32 s59, s59, 16384
    s_waitcnt lgkmcnt(6)
    v_mfma_f32_16x16x32_bf16 v[80:83], v[112:115], v[96:99], v[80:83]
    ds_read_b64_tr_b16 v[132:133], v27 offset:40960
    v_mfma_f32_16x16x32_bf16 v[84:87], v[112:115], v[100:103], v[84:87]
    ds_read_b64_tr_b16 v[134:135], v27 offset:41984
    ds_read_b64_tr_b16 v[136:137], v28 offset:40960
    s_add_u32 s64, s68, 81920
    s_mov_b32 m0, s64
    s_nop 0
    buffer_load_dwordx4 v4, s[24:27], s60 offen nt lds
    s_waitcnt lgkmcnt(7)
    v_mfma_f32_16x16x32_bf16 v[88:91], v[116:119], v[96:99], v[88:91]
    ds_read_b64_tr_b16 v[138:139], v28 offset:41984
    v_mfma_f32_16x16x32_bf16 v[92:95], v[116:119], v[100:103], v[92:95]
    ds_read_b64_tr_b16 v[140:141], v29 offset:40960
    ds_read_b64_tr_b16 v[142:143], v29 offset:41984
    buffer_load_dwordx4 v5, s[24:27], s60 offen offset:1024 nt lds
    s_add_u32 s60, s60, 16384
    s_waitcnt lgkmcnt(6)
    v_mfma_f32_16x16x32_bf16 v[64:67], v[128:131], v[120:123], v[64:67]
    v_mfma_f32_16x16x32_bf16 v[68:71], v[128:131], v[124:127], v[68:71]
    s_waitcnt lgkmcnt(4)
    v_mfma_f32_16x16x32_bf16 v[72:75], v[132:135], v[120:123], v[72:75]
    v_mfma_f32_16x16x32_bf16 v[76:79], v[132:135], v[124:127], v[76:79]
    s_waitcnt lgkmcnt(2)
    v_mfma_f32_16x16x32_bf16 v[80:83], v[136:139], v[120:123], v[80:83]
    v_mfma_f32_16x16x32_bf16 v[84:87], v[136:139], v[124:127], v[84:87]
    s_waitcnt lgkmcnt(0)
    v_mfma_f32_16x16x32_bf16 v[88:91], v[140:143], v[120:123], v[88:91]
    v_mfma_f32_16x16x32_bf16 v[92:95], v[140:143], v[124:127], v[92:95]
    s_mov_b32 s64, 65536
    v_add_u32 v24, s64, v24
    v_add_u32 v25, s64, v25
    v_add_u32 v26, s64, v26
    v_add_u32 v27, s64, v27
    v_add_u32 v28, s64, v28
    v_add_u32 v29, s64, v29
    s_waitcnt vmcnt(4) lgkmcnt(0)
    s_barrier
    ds_read_b128 v[144:147], v24 offset:0
    ds_read_b128 v[148:151], v24 offset:2048
    ds_read_b64_tr_b16 v[152:153], v26 offset:0
    ds_read_b64_tr_b16 v[154:155], v26 offset:1024
    ds_read_b64_tr_b16 v[156:157], v27 offset:0
    ds_read_b64_tr_b16 v[158:159], v27 offset:1024
    ds_read_b64_tr_b16 v[160:161], v28 offset:0
    ds_read_b64_tr_b16 v[162:163], v28 offset:1024
    s_waitcnt lgkmcnt(4)
    v_mfma_f32_16x16x32_bf16 v[64:67], v[152:155], v[144:147], v[64:67]
    ds_read_b64_tr_b16 v[164:165], v29 offset:0
    v_mfma_f32_16x16x32_bf16 v[68:71], v[152:155], v[148:151], v[68:71]
    ds_read_b64_tr_b16 v[166:167], v29 offset:1024
    ds_read_b128 v[168:171], v25 offset:0
    v_mov_b32 v96, 0
    v_mov_b32 v97, 0
    v_mov_b32 v98, 0
    v_mov_b32 v99, 0
    s_waitcnt lgkmcnt(5)
    v_mfma_f32_16x16x32_bf16 v[72:75], v[156:159], v[144:147], v[72:75]
    ds_read_b128 v[172:175], v25 offset:2048
    v_mfma_f32_16x16x32_bf16 v[76:79], v[156:159], v[148:151], v[76:79]
    ds_read_b64_tr_b16 v[176:177], v26 offset:8192
    ds_read_b64_tr_b16 v[178:179], v26 offset:9216
    v_mov_b32 v100, 0
    v_mov_b32 v101, 0
    v_mov_b32 v102, 0
    v_mov_b32 v103, 0
    s_waitcnt lgkmcnt(6)
    v_mfma_f32_16x16x32_bf16 v[80:83], v[160:163], v[144:147], v[80:83]
    ds_read_b64_tr_b16 v[180:181], v27 offset:8192
    v_mfma_f32_16x16x32_bf16 v[84:87], v[160:163], v[148:151], v[84:87]
    ds_read_b64_tr_b16 v[182:183], v27 offset:9216
    ds_read_b64_tr_b16 v[184:185], v28 offset:8192
    v_mov_b32 v104, 0
    v_mov_b32 v105, 0
    v_mov_b32 v106, 0
    v_mov_b32 v107, 0
    s_waitcnt lgkmcnt(7)
    v_mfma_f32_16x16x32_bf16 v[88:91], v[164:167], v[144:147], v[88:91]
    ds_read_b64_tr_b16 v[186:187], v28 offset:9216
    v_mfma_f32_16x16x32_bf16 v[92:95], v[164:167], v[148:151], v[92:95]
    ds_read_b64_tr_b16 v[188:189], v29 offset:8192
    ds_read_b64_tr_b16 v[190:191], v29 offset:9216
    v_mov_b32 v108, 0
    v_mov_b32 v109, 0
    v_mov_b32 v110, 0
    v_mov_b32 v111, 0
    s_waitcnt lgkmcnt(6)
    v_mfma_f32_16x16x32_bf16 v[64:67], v[176:179], v[168:171], v[64:67]
    v_mfma_f32_16x16x32_bf16 v[68:71], v[176:179], v[172:175], v[68:71]
    v_mov_b32 v112, 0
    v_mov_b32 v113, 0
    v_mov_b32 v114, 0
    v_mov_b32 v115, 0
    s_waitcnt lgkmcnt(4)
    v_mfma_f32_16x16x32_bf16 v[72:75], v[180:183], v[168:171], v[72:75]
    v_mfma_f32_16x16x32_bf16 v[76:79], v[180:183], v[172:175], v[76:79]
    v_mov_b32 v116, 0
    v_mov_b32 v117, 0
    v_mov_b32 v118, 0
    v_mov_b32 v119, 0
    s_waitcnt lgkmcnt(2)
    v_mfma_f32_16x16x32_bf16 v[80:83], v[184:187], v[168:171], v[80:83]
    v_mfma_f32_16x16x32_bf16 v[84:87], v[184:187], v[172:175], v[84:87]
    v_mov_b32 v120, 0
    v_mov_b32 v121, 0
    v_mov_b32 v122, 0
    v_mov_b32 v123, 0
    s_waitcnt lgkmcnt(0)
    v_mfma_f32_16x16x32_bf16 v[88:91], v[188:191], v[168:171], v[88:91]
    v_mfma_f32_16x16x32_bf16 v[92:95], v[188:191], v[172:175], v[92:95]
    v_mov_b32 v124, 0
    v_mov_b32 v125, 0
    v_mov_b32 v126, 0
    v_mov_b32 v127, 0
    s_barrier
    v_lshrrev_b32 v246, 1, v240
    v_xor_b32 v246, v246, v241
    v_lshlrev_b32 v246, 4, v246
    v_lshl_add_u32 v246, v241, 8, v246
    v_and_b32 v247, 1, v240
    v_lshl_add_u32 v246, v247, 3, v246
    s_lshl_b32 s64, s53, 13
    s_add_u32 s64, s64, 131072
    s_lshl_b32 s65, s54, 7
    v_xor_b32 v246, s65, v246
    v_add_u32 v246, s64, v246
    v_add_u32 v242, s64, v242
    v_xor_b32 v247, 0, v246
    v_mul_f32 v64, s57, v64
    v_mul_f32 v65, s57, v65
    v_mul_f32 v66, s57, v66
    v_mul_f32 v67, s57, v67
    v_cvt_pk_bf16_f32 v32, v64, v65
    v_cvt_pk_bf16_f32 v33, v66, v67
    ds_write_b64 v247, v[32:33] offset:0
    v_mul_f32 v68, s57, v68
    v_mul_f32 v69, s57, v69
    v_mul_f32 v70, s57, v70
    v_mul_f32 v71, s57, v71
    v_cvt_pk_bf16_f32 v34, v68, v69
    v_cvt_pk_bf16_f32 v35, v70, v71
    ds_write_b64 v247, v[34:35] offset:4096
    v_xor_b32 v247, 32, v246
    v_mul_f32 v72, s57, v72
    v_mul_f32 v73, s57, v73
    v_mul_f32 v74, s57, v74
    v_mul_f32 v75, s57, v75
    v_cvt_pk_bf16_f32 v36, v72, v73
    v_cvt_pk_bf16_f32 v37, v74, v75
    ds_write_b64 v247, v[36:37] offset:0
    v_mul_f32 v76, s57, v76
    v_mul_f32 v77, s57, v77
    v_mul_f32 v78, s57, v78
    v_mul_f32 v79, s57, v79
    v_cvt_pk_bf16_f32 v38, v76, v77
    v_cvt_pk_bf16_f32 v39, v78, v79
    ds_write_b64 v247, v[38:39] offset:4096
    v_xor_b32 v247, 64, v246
    v_mul_f32 v80, s57, v80
    v_mul_f32 v81, s57, v81
    v_mul_f32 v82, s57, v82
    v_mul_f32 v83, s57, v83
    v_cvt_pk_bf16_f32 v40, v80, v81
    v_cvt_pk_bf16_f32 v41, v82, v83
    ds_write_b64 v247, v[40:41] offset:0
    v_mul_f32 v84, s57, v84
    v_mul_f32 v85, s57, v85
    v_mul_f32 v86, s57, v86
    v_mul_f32 v87, s57, v87
    v_cvt_pk_bf16_f32 v42, v84, v85
    v_cvt_pk_bf16_f32 v43, v86, v87
    ds_write_b64 v247, v[42:43] offset:4096
    v_xor_b32 v247, 96, v246
    v_mul_f32 v88, s57, v88
    v_mul_f32 v89, s57, v89
    v_mul_f32 v90, s57, v90
    v_mul_f32 v91, s57, v91
    v_cvt_pk_bf16_f32 v44, v88, v89
    v_cvt_pk_bf16_f32 v45, v90, v91
    ds_write_b64 v247, v[44:45] offset:0
    v_mul_f32 v92, s57, v92
    v_mul_f32 v93, s57, v93
    v_mul_f32 v94, s57, v94
    v_mul_f32 v95, s57, v95
    v_cvt_pk_bf16_f32 v46, v92, v93
    v_cvt_pk_bf16_f32 v47, v94, v95
    ds_write_b64 v247, v[46:47] offset:4096
    v_mov_b32 v12, 0x3f803f80
    v_mov_b32 v13, 0x3f803f80
    v_mov_b32 v14, 0x3f803f80
    v_mov_b32 v15, 0x3f803f80
    v_mov_b32 v64, 0
    v_mov_b32 v65, 0
    v_mov_b32 v66, 0
    v_mov_b32 v67, 0
    v_mov_b32 v68, 0
    v_mov_b32 v69, 0
    v_mov_b32 v70, 0
    v_mov_b32 v71, 0
    v_mov_b32 v72, 0
    v_mov_b32 v73, 0
    v_mov_b32 v74, 0
    v_mov_b32 v75, 0
    v_mov_b32 v76, 0
    v_mov_b32 v77, 0
    v_mov_b32 v78, 0
    v_mov_b32 v79, 0
    v_mov_b32 v80, 0
    v_mov_b32 v81, 0
    v_mov_b32 v82, 0
    v_mov_b32 v83, 0
    v_mov_b32 v84, 0
    v_mov_b32 v85, 0
    v_mov_b32 v86, 0
    v_mov_b32 v87, 0
    v_mov_b32 v88, 0
    v_mov_b32 v89, 0
    v_mov_b32 v90, 0
    v_mov_b32 v91, 0
    v_mov_b32 v92, 0
    v_mov_b32 v93, 0
    v_mov_b32 v94, 0
    v_mov_b32 v95, 0
    s_mov_b32 s61, 0
    v_xor_b32 v249, 64, v242
    v_xor_b32 v250, 128, v242
    v_xor_b32 v251, 192, v242
    s_waitcnt vmcnt(4) lgkmcnt(0)
    s_barrier
    ds_read_b128 v[32:35], v242 offset:0
    ds_read_b128 v[36:39], v249 offset:0
    ds_read_b128 v[40:43], v250 offset:0
    ds_read_b128 v[44:47], v251 offset:0
    ds_read_b128 v[48:51], v242 offset:4096
    ds_read_b128 v[52:55], v249 offset:4096
    ds_read_b128 v[56:59], v250 offset:4096
    ds_read_b128 v[60:63], v251 offset:4096
    s_waitcnt lgkmcnt(4)
    ds_read_b128 v[168:171], v8 offset:0
    ds_read_b128 v[172:175], v9 offset:0
    ds_read_b128 v[176:179], v10 offset:0
    ds_read_b128 v[180:183], v11 offset:0
    ds_read_b128 v[184:187], v8 offset:4096
    ds_read_b128 v[188:191], v9 offset:4096
    ds_read_b128 v[192:195], v10 offset:4096
    ds_read_b128 v[196:199], v11 offset:4096
    v_mov_b32 v248, 0
    v_mov_b32 v249, 0
    v_mov_b32 v250, 0
    v_mov_b32 v251, 0
    v_mov_b32 v252, 0
    v_mov_b32 v253, 0
    v_mov_b32 v254, 0
    v_mov_b32 v255, 0
    s_waitcnt vmcnt(4) lgkmcnt(0)
    s_barrier
    v_mfma_f32_16x16x32_bf16 v[128:131], v[168:171], v[32:35], 0
    s_add_u32 s64, s68, 0
    s_mov_b32 m0, s64
    s_nop 0
    buffer_load_dwordx4 v2, s[20:23], s59 offen nt lds
    v_mfma_f32_16x16x32_bf16 v[128:131], v[172:175], v[36:39], v[128:131]
    v_mfma_f32_16x16x32_bf16 v[128:131], v[176:179], v[40:43], v[128:131]
    buffer_load_dwordx4 v3, s[20:23], s59 offen offset:1024 nt lds
    s_add_u32 s59, s59, 16384
    v_mfma_f32_16x16x32_bf16 v[128:131], v[180:183], v[44:47], v[128:131]
    v_mfma_f32_16x16x32_bf16 v[132:135], v[168:171], v[48:51], 0
    s_add_u32 s64, s68, 49152
    s_mov_b32 m0, s64
    s_nop 0
    buffer_load_dwordx4 v4, s[24:27], s60 offen nt lds
    v_mfma_f32_16x16x32_bf16 v[132:135], v[172:175], v[52:55], v[132:135]
    v_mfma_f32_16x16x32_bf16 v[132:135], v[176:179], v[56:59], v[132:135]
    buffer_load_dwordx4 v5, s[24:27], s60 offen offset:1024 nt lds
    s_add_u32 s60, s60, 16384
    v_mfma_f32_16x16x32_bf16 v[132:135], v[180:183], v[60:63], v[132:135]
    v_mfma_f32_16x16x32_bf16 v[136:139], v[184:187], v[32:35], 0
    v_mfma_f32_16x16x32_bf16 v[136:139], v[188:191], v[36:39], v[136:139]
    v_mfma_f32_16x16x32_bf16 v[136:139], v[192:195], v[40:43], v[136:139]
    v_mfma_f32_16x16x32_bf16 v[136:139], v[196:199], v[44:47], v[136:139]
    v_mfma_f32_16x16x32_bf16 v[140:143], v[184:187], v[48:51], 0
    v_mfma_f32_16x16x32_bf16 v[140:143], v[188:191], v[52:55], v[140:143]
    v_mfma_f32_16x16x32_bf16 v[140:143], v[192:195], v[56:59], v[140:143]
    v_mfma_f32_16x16x32_bf16 v[140:143], v[196:199], v[60:63], v[140:143]
    ds_read_b128 v[168:171], v8 offset:16384
    ds_read_b128 v[172:175], v9 offset:16384
    ds_read_b128 v[176:179], v10 offset:16384
    ds_read_b128 v[180:183], v11 offset:16384
    ds_read_b128 v[184:187], v8 offset:20480
    ds_read_b128 v[188:191], v9 offset:20480
    ds_read_b128 v[192:195], v10 offset:20480
    ds_read_b128 v[196:199], v11 offset:20480
    s_nop 3
    v_max3_f32 v26, v128, v129, v130
    v_max3_f32 v26, v131, v136, v26
    v_max3_f32 v26, v137, v138, v26
    v_max_f32 v26, v139, v26
    v_max3_f32 v27, v132, v133, v134
    v_max3_f32 v27, v135, v140, v27
    v_max3_f32 v27, v141, v142, v27
    v_max_f32 v27, v143, v27
    v_max_f32 v30, v26, v27
    v_cmp_lt_f32 vcc, 0x41000000, v30
    s_add_u32 s61, s61, 1
    v_mov_b32 v28, v26
    s_nop 1
    v_permlane32_swap_b32 v26, v28
    v_max_f32 v26, v26, v28
    v_mov_b32 v28, v26
    s_nop 1
    v_permlane16_swap_b32 v26, v28
    v_max_f32 v26, v26, v28
    v_mov_b32 v24, v26
    v_sub_f32 v240, 0, v26
    v_sub_f32 v241, 0, v26
    v_sub_f32 v242, 0, v26
    v_sub_f32 v243, 0, v26
    v_sub_f32 v128, v128, v26
    v_sub_f32 v129, v129, v26
    v_sub_f32 v130, v130, v26
    v_sub_f32 v131, v131, v26
    v_sub_f32 v136, v136, v26
    v_sub_f32 v137, v137, v26
    v_sub_f32 v138, v138, v26
    v_sub_f32 v139, v139, v26
    v_mov_b32 v28, v27
    s_nop 1
    v_permlane32_swap_b32 v27, v28
    v_max_f32 v27, v27, v28
    v_mov_b32 v28, v27
    s_nop 1
    v_permlane16_swap_b32 v27, v28
    v_max_f32 v27, v27, v28
    v_mov_b32 v25, v27
    v_sub_f32 v244, 0, v27
    v_sub_f32 v245, 0, v27
    v_sub_f32 v246, 0, v27
    v_sub_f32 v247, 0, v27
    v_sub_f32 v132, v132, v27
    v_sub_f32 v133, v133, v27
    v_sub_f32 v134, v134, v27
    v_sub_f32 v135, v135, v27
    v_sub_f32 v140, v140, v27
    v_sub_f32 v141, v141, v27
    v_sub_f32 v142, v142, v27
    v_sub_f32 v143, v143, v27
.p2align 6
L_loop:
    s_waitcnt vmcnt(4) lgkmcnt(0)
    s_barrier
    v_mfma_f32_16x16x32_bf16 v[144:147], v[168:171], v[32:35], v[240:243]
    s_add_u32 s64, s68, 16384
    s_mov_b32 m0, s64
    s_nop 0
    buffer_load_dwordx4 v2, s[20:23], s59 offen nt lds
    ds_read_b64_tr_b16 v[200:201], v16 offset:32768
    v_exp_f32 v128, v128
    v_mfma_f32_16x16x32_bf16 v[144:147], v[172:175], v[36:39], v[144:147]
    ds_read_b64_tr_b16 v[202:203], v16 offset:36864
    v_exp_f32 v129, v129
    v_mfma_f32_16x16x32_bf16 v[144:147], v[176:179], v[40:43], v[144:147]
    buffer_load_dwordx4 v3, s[20:23], s59 offen offset:1024 nt lds
    s_add_u32 s59, s59, 16384
    ds_read_b64_tr_b16 v[204:205], v17 offset:32768
    v_exp_f32 v130, v130
    v_mfma_f32_16x16x32_bf16 v[144:147], v[180:183], v[44:47], v[144:147]
    ds_read_b64_tr_b16 v[206:207], v17 offset:36864
    v_cvt_pk_bf16_f32 v160, v128, v129
    v_exp_f32 v131, v131
    v_mfma_f32_16x16x32_bf16 v[148:151], v[168:171], v[48:51], v[244:247]
    s_add_u32 s64, s68, 65536
    s_mov_b32 m0, s64
    s_nop 0
    buffer_load_dwordx4 v4, s[24:27], s60 offen nt lds
    ds_read_b64_tr_b16 v[208:209], v18 offset:32768
    v_exp_f32 v136, v136
    v_mfma_f32_16x16x32_bf16 v[148:151], v[172:175], v[52:55], v[148:151]
    ds_read_b64_tr_b16 v[210:211], v18 offset:36864
    v_cvt_pk_bf16_f32 v161, v130, v131
    v_exp_f32 v137, v137
    v_mfma_f32_16x16x32_bf16 v[148:151], v[176:179], v[56:59], v[148:151]
    buffer_load_dwordx4 v5, s[24:27], s60 offen offset:1024 nt lds
    s_add_u32 s60, s60, 16384
    ds_read_b64_tr_b16 v[212:213], v19 offset:32768
    v_exp_f32 v138, v138
    v_mfma_f32_16x16x32_bf16 v[148:151], v[180:183], v[60:63], v[148:151]
    ds_read_b64_tr_b16 v[214:215], v19 offset:36864
    v_cvt_pk_bf16_f32 v162, v136, v137
    v_exp_f32 v139, v139
    v_mfma_f32_16x16x32_bf16 v[152:155], v[184:187], v[32:35], v[240:243]
    ds_read_b64_tr_b16 v[216:217], v20 offset:32768
    v_exp_f32 v132, v132
    v_mfma_f32_16x16x32_bf16 v[152:155], v[188:191], v[36:39], v[152:155]
    ds_read_b64_tr_b16 v[218:219], v20 offset:36864
    v_cvt_pk_bf16_f32 v163, v138, v139
    v_exp_f32 v133, v133
    v_mfma_f32_16x16x32_bf16 v[152:155], v[192:195], v[40:43], v[152:155]
    ds_read_b64_tr_b16 v[220:221], v21 offset:32768
    v_exp_f32 v134, v134
    v_mfma_f32_16x16x32_bf16 v[152:155], v[196:199], v[44:47], v[152:155]
    ds_read_b64_tr_b16 v[222:223], v21 offset:36864
    v_cvt_pk_bf16_f32 v164, v132, v133
    v_exp_f32 v135, v135
    v_mfma_f32_16x16x32_bf16 v[156:159], v[184:187], v[48:51], v[244:247]
    ds_read_b64_tr_b16 v[224:225], v22 offset:32768
    v_exp_f32 v140, v140
    v_mfma_f32_16x16x32_bf16 v[156:159], v[188:191], v[52:55], v[156:159]
    ds_read_b64_tr_b16 v[226:227], v22 offset:36864
    v_cvt_pk_bf16_f32 v165, v134, v135
    v_exp_f32 v141, v141
    v_mfma_f32_16x16x32_bf16 v[156:159], v[192:195], v[56:59], v[156:159]
    ds_read_b64_tr_b16 v[228:229], v23 offset:32768
    v_exp_f32 v142, v142
    v_mfma_f32_16x16x32_bf16 v[156:159], v[196:199], v[60:63], v[156:159]
    s_waitcnt lgkmcnt(14)
    ds_read_b64_tr_b16 v[230:231], v23 offset:36864
    v_cvt_pk_bf16_f32 v166, v140, v141
    v_exp_f32 v143, v143
    s_nop 0
    v_cvt_pk_bf16_f32 v167, v142, v143
    s_nop 1
    v_mfma_f32_16x16x32_bf16 v[248:251], v[12:15], v[160:163], v[248:251]
    v_mfma_f32_16x16x32_bf16 v[252:255], v[12:15], v[164:167], v[252:255]
    s_waitcnt lgkmcnt(14)
    v_mfma_f32_16x16x32_bf16 v[64:67], v[200:203], v[160:163], v[64:67]
    v_mfma_f32_16x16x32_bf16 v[68:71], v[200:203], v[164:167], v[68:71]
    s_waitcnt lgkmcnt(12)
    v_mfma_f32_16x16x32_bf16 v[72:75], v[204:207], v[160:163], v[72:75]
    ds_read_b128 v[168:171], v8 offset:32768
    v_mfma_f32_16x16x32_bf16 v[76:79], v[204:207], v[164:167], v[76:79]
    ds_read_b128 v[172:175], v9 offset:32768
    s_waitcnt lgkmcnt(12)
    v_mfma_f32_16x16x32_bf16 v[80:83], v[208:211], v[160:163], v[80:83]
    ds_read_b128 v[176:179], v10 offset:32768
    v_max3_f32 v26, v144, v145, v146
    v_mfma_f32_16x16x32_bf16 v[84:87], v[208:211], v[164:167], v[84:87]
    ds_read_b128 v[180:183], v11 offset:32768
    v_max3_f32 v26, v147, v152, v26
    s_waitcnt lgkmcnt(12)
    v_mfma_f32_16x16x32_bf16 v[88:91], v[212:215], v[160:163], v[88:91]
    ds_read_b128 v[184:187], v8 offset:36864
    v_max3_f32 v26, v153, v154, v26
    v_mfma_f32_16x16x32_bf16 v[92:95], v[212:215], v[164:167], v[92:95]
    ds_read_b128 v[188:191], v9 offset:36864
    v_max_f32 v26, v155, v26
    s_waitcnt lgkmcnt(12)
    v_mfma_f32_16x16x32_bf16 v[96:99], v[216:219], v[160:163], v[96:99]
    ds_read_b128 v[192:195], v10 offset:36864
    v_max3_f32 v27, v148, v149, v150
    v_mfma_f32_16x16x32_bf16 v[100:103], v[216:219], v[164:167], v[100:103]
    ds_read_b128 v[196:199], v11 offset:36864
    v_max3_f32 v27, v151, v156, v27
    s_waitcnt lgkmcnt(12)
    v_mfma_f32_16x16x32_bf16 v[104:107], v[220:223], v[160:163], v[104:107]
    v_max3_f32 v27, v157, v158, v27
    v_mfma_f32_16x16x32_bf16 v[108:111], v[220:223], v[164:167], v[108:111]
    v_max_f32 v27, v159, v27
    s_waitcnt lgkmcnt(10)
    v_mfma_f32_16x16x32_bf16 v[112:115], v[224:227], v[160:163], v[112:115]
    v_max_f32 v30, v26, v27
    v_mfma_f32_16x16x32_bf16 v[116:119], v[224:227], v[164:167], v[116:119]
    v_cmp_lt_f32 vcc, 0x41000000, v30
    s_waitcnt lgkmcnt(8)
    v_mfma_f32_16x16x32_bf16 v[120:123], v[228:231], v[160:163], v[120:123]
    v_mfma_f32_16x16x32_bf16 v[124:127], v[228:231], v[164:167], v[124:127]
    s_add_u32 s61, s61, 1
    s_cbranch_vccnz L_resc_l0
L_back_l0:
    s_waitcnt vmcnt(4) lgkmcnt(0)
    s_barrier
    v_mfma_f32_16x16x32_bf16 v[128:131], v[168:171], v[32:35], v[240:243]
    s_add_u32 s64, s68, 32768
    s_mov_b32 m0, s64
    s_nop 0
    buffer_load_dwordx4 v2, s[20:23], s59 offen nt lds
    ds_read_b64_tr_b16 v[200:201], v16 offset:0
    v_exp_f32 v144, v144
    v_mfma_f32_16x16x32_bf16 v[128:131], v[172:175], v[36:39], v[128:131]
    ds_read_b64_tr_b16 v[202:203], v16 offset:4096
    v_exp_f32 v145, v145
    v_mfma_f32_16x16x32_bf16 v[128:131], v[176:179], v[40:43], v[128:131]
    buffer_load_dwordx4 v3, s[20:23], s59 offen offset:1024 nt lds
    s_add_u32 s59, s59, 16384
    ds_read_b64_tr_b16 v[204:205], v17 offset:0
    v_exp_f32 v146, v146
    v_mfma_f32_16x16x32_bf16 v[128:131], v[180:183], v[44:47], v[128:131]
    ds_read_b64_tr_b16 v[206:207], v17 offset:4096
    v_cvt_pk_bf16_f32 v160, v144, v145
    v_exp_f32 v147, v147
    v_mfma_f32_16x16x32_bf16 v[132:135], v[168:171], v[48:51], v[244:247]
    s_add_u32 s64, s68, 81920
    s_mov_b32 m0, s64
    s_nop 0
    buffer_load_dwordx4 v4, s[24:27], s60 offen nt lds
    ds_read_b64_tr_b16 v[208:209], v18 offset:0
    v_exp_f32 v152, v152
    v_mfma_f32_16x16x32_bf16 v[132:135], v[172:175], v[52:55], v[132:135]
    ds_read_b64_tr_b16 v[210:211], v18 offset:4096
    v_cvt_pk_bf16_f32 v161, v146, v147
    v_exp_f32 v153, v153
    v_mfma_f32_16x16x32_bf16 v[132:135], v[176:179], v[56:59], v[132:135]
    buffer_load_dwordx4 v5, s[24:27], s60 offen offset:1024 nt lds
    s_add_u32 s60, s60, 16384
    ds_read_b64_tr_b16 v[212:213], v19 offset:0
    v_exp_f32 v154, v154
    v_mfma_f32_16x16x32_bf16 v[132:135], v[180:183], v[60:63], v[132:135]
    ds_read_b64_tr_b16 v[214:215], v19 offset:4096
    v_cvt_pk_bf16_f32 v162, v152, v153
    v_exp_f32 v155, v155
    v_mfma_f32_16x16x32_bf16 v[136:139], v[184:187], v[32:35], v[240:243]
    ds_read_b64_tr_b16 v[216:217], v20 offset:0
    v_exp_f32 v148, v148
    v_mfma_f32_16x16x32_bf16 v[136:139], v[188:191], v[36:39], v[136:139]
    ds_read_b64_tr_b16 v[218:219], v20 offset:4096
    v_cvt_pk_bf16_f32 v163, v154, v155
    v_exp_f32 v149, v149
    v_mfma_f32_16x16x32_bf16 v[136:139], v[192:195], v[40:43], v[136:139]
    ds_read_b64_tr_b16 v[220:221], v21 offset:0
    v_exp_f32 v150, v150
    v_mfma_f32_16x16x32_bf16 v[136:139], v[196:199], v[44:47], v[136:139]
    ds_read_b64_tr_b16 v[222:223], v21 offset:4096
    v_cvt_pk_bf16_f32 v164, v148, v149
    v_exp_f32 v151, v151
    v_mfma_f32_16x16x32_bf16 v[140:143], v[184:187], v[48:51], v[244:247]
    ds_read_b64_tr_b16 v[224:225], v22 offset:0
    v_exp_f32 v156, v156
    v_mfma_f32_16x16x32_bf16 v[140:143], v[188:191], v[52:55], v[140:143]
    ds_read_b64_tr_b16 v[226:227], v22 offset:4096
    v_cvt_pk_bf16_f32 v165, v150, v151
    v_exp_f32 v157, v157
    v_mfma_f32_16x16x32_bf16 v[140:143], v[192:195], v[56:59], v[140:143]
    ds_read_b64_tr_b16 v[228:229], v23 offset:0
    v_exp_f32 v158, v158
    v_mfma_f32_16x16x32_bf16 v[140:143], v[196:199], v[60:63], v[140:143]
    s_waitcnt lgkmcnt(14)
    ds_read_b64_tr_b16 v[230:231], v23 offset:4096
    v_cvt_pk_bf16_f32 v166, v156, v157
    v_exp_f32 v159, v159
    s_nop 0
    v_cvt_pk_bf16_f32 v167, v158, v159
    s_nop 1
    v_mfma_f32_16x16x32_bf16 v[248:251], v[12:15], v[160:163], v[248:251]
    v_mfma_f32_16x16x32_bf16 v[252:255], v[12:15], v[164:167], v[252:255]
    s_waitcnt lgkmcnt(14)
    v_mfma_f32_16x16x32_bf16 v[64:67], v[200:203], v[160:163], v[64:67]
    v_mfma_f32_16x16x32_bf16 v[68:71], v[200:203], v[164:167], v[68:71]
    s_waitcnt lgkmcnt(12)
    v_mfma_f32_16x16x32_bf16 v[72:75], v[204:207], v[160:163], v[72:75]
    ds_read_b128 v[168:171], v8 offset:0
    v_mfma_f32_16x16x32_bf16 v[76:79], v[204:207], v[164:167], v[76:79]
    ds_read_b128 v[172:175], v9 offset:0
    s_waitcnt lgkmcnt(12)
    v_mfma_f32_16x16x32_bf16 v[80:83], v[208:211], v[160:163], v[80:83]
    ds_read_b128 v[176:179], v10 offset:0
    v_max3_f32 v26, v128, v129, v130
    v_mfma_f32_16x16x32_bf16 v[84:87], v[208:211], v[164:167], v[84:87]
    ds_read_b128 v[180:183], v11 offset:0
    v_max3_f32 v26, v131, v136, v26
    s_waitcnt lgkmcnt(12)
    v_mfma_f32_16x16x32_bf16 v[88:91], v[212:215], v[160:163], v[88:91]
    ds_read_b128 v[184:187], v8 offset:4096
    v_max3_f32 v26, v137, v138, v26
    v_mfma_f32_16x16x32_bf16 v[92:95], v[212:215], v[164:167], v[92:95]
    ds_read_b128 v[188:191], v9 offset:4096
    v_max_f32 v26, v139, v26
    s_waitcnt lgkmcnt(12)
    v_mfma_f32_16x16x32_bf16 v[96:99], v[216:219], v[160:163], v[96:99]
    ds_read_b128 v[192:195], v10 offset:4096
    v_max3_f32 v27, v132, v133, v134
    v_mfma_f32_16x16x32_bf16 v[100:103], v[216:219], v[164:167], v[100:103]
    ds_read_b128 v[196:199], v11 offset:4096
    v_max3_f32 v27, v135, v140, v27
    s_waitcnt lgkmcnt(12)
    v_mfma_f32_16x16x32_bf16 v[104:107], v[220:223], v[160:163], v[104:107]
    v_max3_f32 v27, v141, v142, v27
    v_mfma_f32_16x16x32_bf16 v[108:111], v[220:223], v[164:167], v[108:111]
    v_max_f32 v27, v143, v27
    s_waitcnt lgkmcnt(10)
    v_mfma_f32_16x16x32_bf16 v[112:115], v[224:227], v[160:163], v[112:115]
    v_max_f32 v30, v26, v27
    v_mfma_f32_16x16x32_bf16 v[116:119], v[224:227], v[164:167], v[116:119]
    v_cmp_lt_f32 vcc, 0x41000000, v30
    s_waitcnt lgkmcnt(8)
    v_mfma_f32_16x16x32_bf16 v[120:123], v[228:231], v[160:163], v[120:123]
    v_mfma_f32_16x16x32_bf16 v[124:127], v[228:231], v[164:167], v[124:127]
    s_add_u32 s61, s61, 1
    s_cbranch_vccnz L_resc_l1
L_back_l1:
    s_waitcnt vmcnt(4) lgkmcnt(0)
    s_barrier
    v_mfma_f32_16x16x32_bf16 v[144:147], v[168:171], v[32:35], v[240:243]
    s_add_u32 s64, s68, 0
    s_mov_b32 m0, s64
    s_nop 0
    buffer_load_dwordx4 v2, s[20:23], s59 offen nt lds
    ds_read_b64_tr_b16 v[200:201], v16 offset:16384
    v_exp_f32 v128, v128
    v_mfma_f32_16x16x32_bf16 v[144:147], v[172:175], v[36:39], v[144:147]
    ds_read_b64_tr_b16 v[202:203], v16 offset:20480
    v_exp_f32 v129, v129
    v_mfma_f32_16x16x32_bf16 v[144:147], v[176:179], v[40:43], v[144:147]
    buffer_load_dwordx4 v3, s[20:23], s59 offen offset:1024 nt lds
    s_add_u32 s59, s59, 16384
    ds_read_b64_tr_b16 v[204:205], v17 offset:16384
    v_exp_f32 v130, v130
    v_mfma_f32_16x16x32_bf16 v[144:147], v[180:183], v[44:47], v[144:147]
    ds_read_b64_tr_b16 v[206:207], v17 offset:20480
    v_cvt_pk_bf16_f32 v160, v128, v129
    v_exp_f32 v131, v131
    v_mfma_f32_16x16x32_bf16 v[148:151], v[168:171], v[48:51], v[244:247]
    s_add_u32 s64, s68, 49152
    s_mov_b32 m0, s64
    s_nop 0
    buffer_load_dwordx4 v4, s[24:27], s60 offen nt lds
    ds_read_b64_tr_b16 v[208:209], v18 offset:16384
    v_exp_f32 v136, v136
    v_mfma_f32_16x16x32_bf16 v[148:151], v[172:175], v[52:55], v[148:151]
    ds_read_b64_tr_b16 v[210:211], v18 offset:20480
    v_cvt_pk_bf16_f32 v161, v130, v131
    v_exp_f32 v137, v137
    v_mfma_f32_16x16x32_bf16 v[148:151], v[176:179], v[56:59], v[148:151]
    buffer_load_dwordx4 v5, s[24:27], s60 offen offset:1024 nt lds
    s_add_u32 s60, s60, 16384
    ds_read_b64_tr_b16 v[212:213], v19 offset:16384
    v_exp_f32 v138, v138
    v_mfma_f32_16x16x32_bf16 v[148:151], v[180:183], v[60:63], v[148:151]
    ds_read_b64_tr_b16 v[214:215], v19 offset:20480
    v_cvt_pk_bf16_f32 v162, v136, v137
    v_exp_f32 v139, v139
    v_mfma_f32_16x16x32_bf16 v[152:155], v[184:187], v[32:35], v[240:243]
    ds_read_b64_tr_b16 v[216:217], v20 offset:16384
    v_exp_f32 v132, v132
    v_mfma_f32_16x16x32_bf16 v[152:155], v[188:191], v[36:39], v[152:155]
    ds_read_b64_tr_b16 v[218:219], v20 offset:20480
    v_cvt_pk_bf16_f32 v163, v138, v139
    v_exp_f32 v133, v133
    v_mfma_f32_16x16x32_bf16 v[152:155], v[192:195], v[40:43], v[152:155]
    ds_read_b64_tr_b16 v[220:221], v21 offset:16384
    v_exp_f32 v134, v134
    v_mfma_f32_16x16x32_bf16 v[152:155], v[196:199], v[44:47], v[152:155]
    ds_read_b64_tr_b16 v[222:223], v21 offset:20480
    v_cvt_pk_bf16_f32 v164, v132, v133
    v_exp_f32 v135, v135
    v_mfma_f32_16x16x32_bf16 v[156:159], v[184:187], v[48:51], v[244:247]
    ds_read_b64_tr_b16 v[224:225], v22 offset:16384
    v_exp_f32 v140, v140
    v_mfma_f32_16x16x32_bf16 v[156:159], v[188:191], v[52:55], v[156:159]
    ds_read_b64_tr_b16 v[226:227], v22 offset:20480
    v_cvt_pk_bf16_f32 v165, v134, v135
    v_exp_f32 v141, v141
    v_mfma_f32_16x16x32_bf16 v[156:159], v[192:195], v[56:59], v[156:159]
    ds_read_b64_tr_b16 v[228:229], v23 offset:16384
    v_exp_f32 v142, v142
    v_mfma_f32_16x16x32_bf16 v[156:159], v[196:199], v[60:63], v[156:159]
    s_waitcnt lgkmcnt(14)
    ds_read_b64_tr_b16 v[230:231], v23 offset:20480
    v_cvt_pk_bf16_f32 v166, v140, v141
    v_exp_f32 v143, v143
    s_nop 0
    v_cvt_pk_bf16_f32 v167, v142, v143
    s_nop 1
    v_mfma_f32_16x16x32_bf16 v[248:251], v[12:15], v[160:163], v[248:251]
    v_mfma_f32_16x16x32_bf16 v[252:255], v[12:15], v[164:167], v[252:255]
    s_waitcnt lgkmcnt(14)
    v_mfma_f32_16x16x32_bf16 v[64:67], v[200:203], v[160:163], v[64:67]
    v_mfma_f32_16x16x32_bf16 v[68:71], v[200:203], v[164:167], v[68:71]
    s_waitcnt lgkmcnt(12)
    v_mfma_f32_16x16x32_bf16 v[72:75], v[204:207], v[160:163], v[72:75]
    ds_read_b128 v[168:171], v8 offset:16384
    v_mfma_f32_16x16x32_bf16 v[76:79], v[204:207], v[164:167], v[76:79]
    ds_read_b128 v[172:175], v9 offset:16384
    s_waitcnt lgkmcnt(12)
    v_mfma_f32_16x16x32_bf16 v[80:83], v[208:211], v[160:163], v[80:83]
    ds_read_b128 v[176:179], v10 offset:16384
    v_max3_f32 v26, v144, v145, v146
    v_mfma_f32_16x16x32_bf16 v[84:87], v[208:211], v[164:167], v[84:87]
    ds_read_b128 v[180:183], v11 offset:16384
    v_max3_f32 v26, v147, v152, v26
    s_waitcnt lgkmcnt(12)
    v_mfma_f32_16x16x32_bf16 v[88:91], v[212:215], v[160:163], v[88:91]
    ds_read_b128 v[184:187], v8 offset:20480
    v_max3_f32 v26, v153, v154, v26
    v_mfma_f32_16x16x32_bf16 v[92:95], v[212:215], v[164:167], v[92:95]
    ds_read_b128 v[188:191], v9 offset:20480
    v_max_f32 v26, v155, v26
    s_waitcnt lgkmcnt(12)
    v_mfma_f32_16x16x32_bf16 v[96:99], v[216:219], v[160:163], v[96:99]
    ds_read_b128 v[192:195], v10 offset:20480
    v_max3_f32 v27, v148, v149, v150
    v_mfma_f32_16x16x32_bf16 v[100:103], v[216:219], v[164:167], v[100:103]
    ds_read_b128 v[196:199], v11 offset:20480
    v_max3_f32 v27, v151, v156, v27
    s_waitcnt lgkmcnt(12)
    v_mfma_f32_16x16x32_bf16 v[104:107], v[220:223], v[160:163], v[104:107]
    v_max3_f32 v27, v157, v158, v27
    v_mfma_f32_16x16x32_bf16 v[108:111], v[220:223], v[164:167], v[108:111]
    v_max_f32 v27, v159, v27
    s_waitcnt lgkmcnt(10)
    v_mfma_f32_16x16x32_bf16 v[112:115], v[224:227], v[160:163], v[112:115]
    v_max_f32 v30, v26, v27
    v_mfma_f32_16x16x32_bf16 v[116:119], v[224:227], v[164:167], v[116:119]
    v_cmp_lt_f32 vcc, 0x41000000, v30
    s_waitcnt lgkmcnt(8)
    v_mfma_f32_16x16x32_bf16 v[120:123], v[228:231], v[160:163], v[120:123]
    v_mfma_f32_16x16x32_bf16 v[124:127], v[228:231], v[164:167], v[124:127]
    s_add_u32 s61, s61, 1
    s_cbranch_vccnz L_resc_l2
L_back_l2:
    s_waitcnt vmcnt(4) lgkmcnt(0)
    s_barrier
    v_mfma_f32_16x16x32_bf16 v[128:131], v[168:171], v[32:35], v[240:243]
    s_add_u32 s64, s68, 16384
    s_mov_b32 m0, s64
    s_nop 0
    buffer_load_dwordx4 v2, s[20:23], s59 offen nt lds
    ds_read_b64_tr_b16 v[200:201], v16 offset:32768
    v_exp_f32 v144, v144
    v_mfma_f32_16x16x32_bf16 v[128:131], v[172:175], v[36:39], v[128:131]
    ds_read_b64_tr_b16 v[202:203], v16 offset:36864
    v_exp_f32 v145, v145
    v_mfma_f32_16x16x32_bf16 v[128:131], v[176:179], v[40:43], v[128:131]
    buffer_load_dwordx4 v3, s[20:23], s59 offen offset:1024 nt lds
    s_add_u32 s59, s59, 16384
    ds_read_b64_tr_b16 v[204:205], v17 offset:32768
    v_exp_f32 v146, v146
    v_mfma_f32_16x16x32_bf16 v[128:131], v[180:183], v[44:47], v[128:131]
    ds_read_b64_tr_b16 v[206:207], v17 offset:36864
    v_cvt_pk_bf16_f32 v160, v144, v145
    v_exp_f32 v147, v147
    v_mfma_f32_16x16x32_bf16 v[132:135], v[168:171], v[48:51], v[244:247]
    s_add_u32 s64, s68, 65536
    s_mov_b32 m0, s64
    s_nop 0
    buffer_load_dwordx4 v4, s[24:27], s60 offen nt lds
    ds_read_b64_tr_b16 v[208:209], v18 offset:32768
    v_exp_f32 v152, v152
    v_mfma_f32_16x16x32_bf16 v[132:135], v[172:175], v[52:55], v[132:135]
    ds_read_b64_tr_b16 v[210:211], v18 offset:36864
    v_cvt_pk_bf16_f32 v161, v146, v147
    v_exp_f32 v153, v153
    v_mfma_f32_16x16x32_bf16 v[132:135], v[176:179], v[56:59], v[132:135]
    buffer_load_dwordx4 v5, s[24:27], s60 offen offset:1024 nt lds
    s_add_u32 s60, s60, 16384
    ds_read_b64_tr_b16 v[212:213], v19 offset:32768
    v_exp_f32 v154, v154
    v_mfma_f32_16x16x32_bf16 v[132:135], v[180:183], v[60:63], v[132:135]
    ds_read_b64_tr_b16 v[214:215], v19 offset:36864
    v_cvt_pk_bf16_f32 v162, v152, v153
    v_exp_f32 v155, v155
    v_mfma_f32_16x16x32_bf16 v[136:139], v[184:187], v[32:35], v[240:243]
    ds_read_b64_tr_b16 v[216:217], v20 offset:32768
    v_exp_f32 v148, v148
    v_mfma_f32_16x16x32_bf16 v[136:139], v[188:191], v[36:39], v[136:139]
    ds_read_b64_tr_b16 v[218:219], v20 offset:36864
    v_cvt_pk_bf16_f32 v163, v154, v155
    v_exp_f32 v149, v149
    v_mfma_f32_16x16x32_bf16 v[136:139], v[192:195], v[40:43], v[136:139]
    ds_read_b64_tr_b16 v[220:221], v21 offset:32768
    v_exp_f32 v150, v150
    v_mfma_f32_16x16x32_bf16 v[136:139], v[196:199], v[44:47], v[136:139]
    ds_read_b64_tr_b16 v[222:223], v21 offset:36864
    v_cvt_pk_bf16_f32 v164, v148, v149
    v_exp_f32 v151, v151
    v_mfma_f32_16x16x32_bf16 v[140:143], v[184:187], v[48:51], v[244:247]
    ds_read_b64_tr_b16 v[224:225], v22 offset:32768
    v_exp_f32 v156, v156
    v_mfma_f32_16x16x32_bf16 v[140:143], v[188:191], v[52:55], v[140:143]
    ds_read_b64_tr_b16 v[226:227], v22 offset:36864
    v_cvt_pk_bf16_f32 v165, v150, v151
    v_exp_f32 v157, v157
    v_mfma_f32_16x16x32_bf16 v[140:143], v[192:195], v[56:59], v[140:143]
    ds_read_b64_tr_b16 v[228:229], v23 offset:32768
    v_exp_f32 v158, v158
    v_mfma_f32_16x16x32_bf16 v[140:143], v[196:199], v[60:63], v[140:143]
    s_waitcnt lgkmcnt(14)
    ds_read_b64_tr_b16 v[230:231], v23 offset:36864
    v_cvt_pk_bf16_f32 v166, v156, v157
    v_exp_f32 v159, v159
    s_nop 0
    v_cvt_pk_bf16_f32 v167, v158, v159
    s_nop 1
    v_mfma_f32_16x16x32_bf16 v[248:251], v[12:15], v[160:163], v[248:251]
    v_mfma_f32_16x16x32_bf16 v[252:255], v[12:15], v[164:167], v[252:255]
    s_waitcnt lgkmcnt(14)
    v_mfma_f32_16x16x32_bf16 v[64:67], v[200:203], v[160:163], v[64:67]
    v_mfma_f32_16x16x32_bf16 v[68:71], v[200:203], v[164:167], v[68:71]
    s_waitcnt lgkmcnt(12)
    v_mfma_f32_16x16x32_bf16 v[72:75], v[204:207], v[160:163], v[72:75]
    ds_read_b128 v[168:171], v8 offset:32768
    v_mfma_f32_16x16x32_bf16 v[76:79], v[204:207], v[164:167], v[76:79]
    ds_read_b128 v[172:175], v9 offset:32768
    s_waitcnt lgkmcnt(12)
    v_mfma_f32_16x16x32_bf16 v[80:83], v[208:211], v[160:163], v[80:83]
    ds_read_b128 v[176:179], v10 offset:32768
    v_max3_f32 v26, v128, v129, v130
    v_mfma_f32_16x16x32_bf16 v[84:87], v[208:211], v[164:167], v[84:87]
    ds_read_b128 v[180:183], v11 offset:32768
    v_max3_f32 v26, v131, v136, v26
    s_waitcnt lgkmcnt(12)
    v_mfma_f32_16x16x32_bf16 v[88:91], v[212:215], v[160:163], v[88:91]
    ds_read_b128 v[184:187], v8 offset:36864
    v_max3_f32 v26, v137, v138, v26
    v_mfma_f32_16x16x32_bf16 v[92:95], v[212:215], v[164:167], v[92:95]
    ds_read_b128 v[188:191], v9 offset:36864
    v_max_f32 v26, v139, v26
    s_waitcnt lgkmcnt(12)
    v_mfma_f32_16x16x32_bf16 v[96:99], v[216:219], v[160:163], v[96:99]
    ds_read_b128 v[192:195], v10 offset:36864
    v_max3_f32 v27, v132, v133, v134
    v_mfma_f32_16x16x32_bf16 v[100:103], v[216:219], v[164:167], v[100:103]
    ds_read_b128 v[196:199], v11 offset:36864
    v_max3_f32 v27, v135, v140, v27
    s_waitcnt lgkmcnt(12)
    v_mfma_f32_16x16x32_bf16 v[104:107], v[220:223], v[160:163], v[104:107]
    v_max3_f32 v27, v141, v142, v27
    v_mfma_f32_16x16x32_bf16 v[108:111], v[220:223], v[164:167], v[108:111]
    v_max_f32 v27, v143, v27
    s_waitcnt lgkmcnt(10)
    v_mfma_f32_16x16x32_bf16 v[112:115], v[224:227], v[160:163], v[112:115]
    v_max_f32 v30, v26, v27
    v_mfma_f32_16x16x32_bf16 v[116:119], v[224:227], v[164:167], v[116:119]
    v_cmp_lt_f32 vcc, 0x41000000, v30
    s_waitcnt lgkmcnt(8)
    v_mfma_f32_16x16x32_bf16 v[120:123], v[228:231], v[160:163], v[120:123]
    v_mfma_f32_16x16x32_bf16 v[124:127], v[228:231], v[164:167], v[124:127]
    s_add_u32 s61, s61, 1
    s_cbranch_vccnz L_resc_l3
L_back_l3:
    s_waitcnt vmcnt(4) lgkmcnt(0)
    s_barrier
    v_mfma_f32_16x16x32_bf16 v[144:147], v[168:171], v[32:35], v[240:243]
    s_add_u32 s64, s68, 32768
    s_mov_b32 m0, s64
    s_nop 0
    buffer_load_dwordx4 v2, s[20:23], s59 offen nt lds
    ds_read_b64_tr_b16 v[200:201], v16 offset:0
    v_exp_f32 v128, v128
    v_mfma_f32_16x16x32_bf16 v[144:147], v[172:175], v[36:39], v[144:147]
    ds_read_b64_tr_b16 v[202:203], v16 offset:4096
    v_exp_f32 v129, v129
    v_mfma_f32_16x16x32_bf16 v[144:147], v[176:179], v[40:43], v[144:147]
    buffer_load_dwordx4 v3, s[20:23], s59 offen offset:1024 nt lds
    s_add_u32 s59, s59, 16384
    ds_read_b64_tr_b16 v[204:205], v17 offset:0
    v_exp_f32 v130, v130
    v_mfma_f32_16x16x32_bf16 v[144:147], v[180:183], v[44:47], v[144:147]
    ds_read_b64_tr_b16 v[206:207], v17 offset:4096
    v_cvt_pk_bf16_f32 v160, v128, v129
    v_exp_f32 v131, v131
    v_mfma_f32_16x16x32_bf16 v[148:151], v[168:171], v[48:51], v[244:247]
    s_add_u32 s64, s68, 81920
    s_mov_b32 m0, s64
    s_nop 0
    buffer_load_dwordx4 v4, s[24:27], s60 offen nt lds
    ds_read_b64_tr_b16 v[208:209], v18 offset:0
    v_exp_f32 v136, v136
    v_mfma_f32_16x16x32_bf16 v[148:151], v[172:175], v[52:55], v[148:151]
    ds_read_b64_tr_b16 v[210:211], v18 offset:4096
    v_cvt_pk_bf16_f32 v161, v130, v131
    v_exp_f32 v137, v137
    v_mfma_f32_16x16x32_bf16 v[148:151], v[176:179], v[56:59], v[148:151]
    buffer_load_dwordx4 v5, s[24:27], s60 offen offset:1024 nt lds
    s_add_u32 s60, s60, 16384
    ds_read_b64_tr_b16 v[212:213], v19 offset:0
    v_exp_f32 v138, v138
    v_mfma_f32_16x16x32_bf16 v[148:151], v[180:183], v[60:63], v[148:151]
    ds_read_b64_tr_b16 v[214:215], v19 offset:4096
    v_cvt_pk_bf16_f32 v162, v136, v137
    v_exp_f32 v139, v139
    v_mfma_f32_16x16x32_bf16 v[152:155], v[184:187], v[32:35], v[240:243]
    ds_read_b64_tr_b16 v[216:217], v20 offset:0
    v_exp_f32 v132, v132
    v_mfma_f32_16x16x32_bf16 v[152:155], v[188:191], v[36:39], v[152:155]
    ds_read_b64_tr_b16 v[218:219], v20 offset:4096
    v_cvt_pk_bf16_f32 v163, v138, v139
    v_exp_f32 v133, v133
    v_mfma_f32_16x16x32_bf16 v[152:155], v[192:195], v[40:43], v[152:155]
    ds_read_b64_tr_b16 v[220:221], v21 offset:0
    v_exp_f32 v134, v134
    v_mfma_f32_16x16x32_bf16 v[152:155], v[196:199], v[44:47], v[152:155]
    ds_read_b64_tr_b16 v[222:223], v21 offset:4096
    v_cvt_pk_bf16_f32 v164, v132, v133
    v_exp_f32 v135, v135
    v_mfma_f32_16x16x32_bf16 v[156:159], v[184:187], v[48:51], v[244:247]
    ds_read_b64_tr_b16 v[224:225], v22 offset:0
    v_exp_f32 v140, v140
    v_mfma_f32_16x16x32_bf16 v[156:159], v[188:191], v[52:55], v[156:159]
    ds_read_b64_tr_b16 v[226:227], v22 offset:4096
    v_cvt_pk_bf16_f32 v165, v134, v135
    v_exp_f32 v141, v141
    v_mfma_f32_16x16x32_bf16 v[156:159], v[192:195], v[56:59], v[156:159]
    ds_read_b64_tr_b16 v[228:229], v23 offset:0
    v_exp_f32 v142, v142
    v_mfma_f32_16x16x32_bf16 v[156:159], v[196:199], v[60:63], v[156:159]
    s_waitcnt lgkmcnt(14)
    ds_read_b64_tr_b16 v[230:231], v23 offset:4096
    v_cvt_pk_bf16_f32 v166, v140, v141
    v_exp_f32 v143, v143
    s_nop 0
    v_cvt_pk_bf16_f32 v167, v142, v143
    s_nop 1
    v_mfma_f32_16x16x32_bf16 v[248:251], v[12:15], v[160:163], v[248:251]
    v_mfma_f32_16x16x32_bf16 v[252:255], v[12:15], v[164:167], v[252:255]
    s_waitcnt lgkmcnt(14)
    v_mfma_f32_16x16x32_bf16 v[64:67], v[200:203], v[160:163], v[64:67]
    v_mfma_f32_16x16x32_bf16 v[68:71], v[200:203], v[164:167], v[68:71]
    s_waitcnt lgkmcnt(12)
    v_mfma_f32_16x16x32_bf16 v[72:75], v[204:207], v[160:163], v[72:75]
    ds_read_b128 v[168:171], v8 offset:0
    v_mfma_f32_16x16x32_bf16 v[76:79], v[204:207], v[164:167], v[76:79]
    ds_read_b128 v[172:175], v9 offset:0
    s_waitcnt lgkmcnt(12)
    v_mfma_f32_16x16x32_bf16 v[80:83], v[208:211], v[160:163], v[80:83]
    ds_read_b128 v[176:179], v10 offset:0
    v_max3_f32 v26, v144, v145, v146
    v_mfma_f32_16x16x32_bf16 v[84:87], v[208:211], v[164:167], v[84:87]
    ds_read_b128 v[180:183], v11 offset:0
    v_max3_f32 v26, v147, v152, v26
    s_waitcnt lgkmcnt(12)
    v_mfma_f32_16x16x32_bf16 v[88:91], v[212:215], v[160:163], v[88:91]
    ds_read_b128 v[184:187], v8 offset:4096
    v_max3_f32 v26, v153, v154, v26
    v_mfma_f32_16x16x32_bf16 v[92:95], v[212:215], v[164:167], v[92:95]
    ds_read_b128 v[188:191], v9 offset:4096
    v_max_f32 v26, v155, v26
    s_waitcnt lgkmcnt(12)
    v_mfma_f32_16x16x32_bf16 v[96:99], v[216:219], v[160:163], v[96:99]
    ds_read_b128 v[192:195], v10 offset:4096
    v_max3_f32 v27, v148, v149, v150
    v_mfma_f32_16x16x32_bf16 v[100:103], v[216:219], v[164:167], v[100:103]
    ds_read_b128 v[196:199], v11 offset:4096
    v_max3_f32 v27, v151, v156, v27
    s_waitcnt lgkmcnt(12)
    v_mfma_f32_16x16x32_bf16 v[104:107], v[220:223], v[160:163], v[104:107]
    v_max3_f32 v27, v157, v158, v27
    v_mfma_f32_16x16x32_bf16 v[108:111], v[220:223], v[164:167], v[108:111]
    v_max_f32 v27, v159, v27
    s_waitcnt lgkmcnt(10)
    v_mfma_f32_16x16x32_bf16 v[112:115], v[224:227], v[160:163], v[112:115]
    v_max_f32 v30, v26, v27
    v_mfma_f32_16x16x32_bf16 v[116:119], v[224:227], v[164:167], v[116:119]
    v_cmp_lt_f32 vcc, 0x41000000, v30
    s_waitcnt lgkmcnt(8)
    v_mfma_f32_16x16x32_bf16 v[120:123], v[228:231], v[160:163], v[120:123]
    v_mfma_f32_16x16x32_bf16 v[124:127], v[228:231], v[164:167], v[124:127]
    s_add_u32 s61, s61, 1
    s_cbranch_vccnz L_resc_l4
L_back_l4:
    s_waitcnt vmcnt(4) lgkmcnt(0)
    s_barrier
    v_mfma_f32_16x16x32_bf16 v[128:131], v[168:171], v[32:35], v[240:243]
    s_add_u32 s64, s68, 0
    s_mov_b32 m0, s64
    s_nop 0
    buffer_load_dwordx4 v2, s[20:23], s59 offen nt lds
    ds_read_b64_tr_b16 v[200:201], v16 offset:16384
    v_exp_f32 v144, v144
    v_mfma_f32_16x16x32_bf16 v[128:131], v[172:175], v[36:39], v[128:131]
    ds_read_b64_tr_b16 v[202:203], v16 offset:20480
    v_exp_f32 v145, v145
    v_mfma_f32_16x16x32_bf16 v[128:131], v[176:179], v[40:43], v[128:131]
    buffer_load_dwordx4 v3, s[20:23], s59 offen offset:1024 nt lds
    s_add_u32 s59, s59, 16384
    ds_read_b64_tr_b16 v[204:205], v17 offset:16384
    v_exp_f32 v146, v146
    v_mfma_f32_16x16x32_bf16 v[128:131], v[180:183], v[44:47], v[128:131]
    ds_read_b64_tr_b16 v[206:207], v17 offset:20480
    v_cvt_pk_bf16_f32 v160, v144, v145
    v_exp_f32 v147, v147
    v_mfma_f32_16x16x32_bf16 v[132:135], v[168:171], v[48:51], v[244:247]
    s_add_u32 s64, s68, 49152
    s_mov_b32 m0, s64
    s_nop 0
    buffer_load_dwordx4 v4, s[24:27], s60 offen nt lds
    ds_read_b64_tr_b16 v[208:209], v18 offset:16384
    v_exp_f32 v152, v152
    v_mfma_f32_16x16x32_bf16 v[132:135], v[172:175], v[52:55], v[132:135]
    ds_read_b64_tr_b16 v[210:211], v18 offset:20480
    v_cvt_pk_bf16_f32 v161, v146, v147
    v_exp_f32 v153, v153
    v_mfma_f32_16x16x32_bf16 v[132:135], v[176:179], v[56:59], v[132:135]
    buffer_load_dwordx4 v5, s[24:27], s60 offen offset:1024 nt lds
    s_add_u32 s60, s60, 16384
    ds_read_b64_tr_b16 v[212:213], v19 offset:16384
    v_exp_f32 v154, v154
    v_mfma_f32_16x16x32_bf16 v[132:135], v[180:183], v[60:63], v[132:135]
    ds_read_b64_tr_b16 v[214:215], v19 offset:20480
    v_cvt_pk_bf16_f32 v162, v152, v153
    v_exp_f32 v155, v155
    v_mfma_f32_16x16x32_bf16 v[136:139], v[184:187], v[32:35], v[240:243]
    ds_read_b64_tr_b16 v[216:217], v20 offset:16384
    v_exp_f32 v148, v148
    v_mfma_f32_16x16x32_bf16 v[136:139], v[188:191], v[36:39], v[136:139]
    ds_read_b64_tr_b16 v[218:219], v20 offset:20480
    v_cvt_pk_bf16_f32 v163, v154, v155
    v_exp_f32 v149, v149
    v_mfma_f32_16x16x32_bf16 v[136:139], v[192:195], v[40:43], v[136:139]
    ds_read_b64_tr_b16 v[220:221], v21 offset:16384
    v_exp_f32 v150, v150
    v_mfma_f32_16x16x32_bf16 v[136:139], v[196:199], v[44:47], v[136:139]
    ds_read_b64_tr_b16 v[222:223], v21 offset:20480
    v_cvt_pk_bf16_f32 v164, v148, v149
    v_exp_f32 v151, v151
    v_mfma_f32_16x16x32_bf16 v[140:143], v[184:187], v[48:51], v[244:247]
    ds_read_b64_tr_b16 v[224:225], v22 offset:16384
    v_exp_f32 v156, v156
    v_mfma_f32_16x16x32_bf16 v[140:143], v[188:191], v[52:55], v[140:143]
    ds_read_b64_tr_b16 v[226:227], v22 offset:20480
    v_cvt_pk_bf16_f32 v165, v150, v151
    v_exp_f32 v157, v157
    v_mfma_f32_16x16x32_bf16 v[140:143], v[192:195], v[56:59], v[140:143]
    ds_read_b64_tr_b16 v[228:229], v23 offset:16384
    v_exp_f32 v158, v158
    v_mfma_f32_16x16x32_bf16 v[140:143], v[196:199], v[60:63], v[140:143]
    s_waitcnt lgkmcnt(14)
    ds_read_b64_tr_b16 v[230:231], v23 offset:20480
    v_cvt_pk_bf16_f32 v166, v156, v157
    v_exp_f32 v159, v159
    s_nop 0
    v_cvt_pk_bf16_f32 v167, v158, v159
    s_nop 1
    v_mfma_f32_16x16x32_bf16 v[248:251], v[12:15], v[160:163], v[248:251]
    v_mfma_f32_16x16x32_bf16 v[252:255], v[12:15], v[164:167], v[252:255]
    s_waitcnt lgkmcnt(14)
    v_mfma_f32_16x16x32_bf16 v[64:67], v[200:203], v[160:163], v[64:67]
    v_mfma_f32_16x16x32_bf16 v[68:71], v[200:203], v[164:167], v[68:71]
    s_waitcnt lgkmcnt(12)
    v_mfma_f32_16x16x32_bf16 v[72:75], v[204:207], v[160:163], v[72:75]
    ds_read_b128 v[168:171], v8 offset:16384
    v_mfma_f32_16x16x32_bf16 v[76:79], v[204:207], v[164:167], v[76:79]
    ds_read_b128 v[172:175], v9 offset:16384
    s_waitcnt lgkmcnt(12)
    v_mfma_f32_16x16x32_bf16 v[80:83], v[208:211], v[160:163], v[80:83]
    ds_read_b128 v[176:179], v10 offset:16384
    v_max3_f32 v26, v128, v129, v130
    v_mfma_f32_16x16x32_bf16 v[84:87], v[208:211], v[164:167], v[84:87]
    ds_read_b128 v[180:183], v11 offset:16384
    v_max3_f32 v26, v131, v136, v26
    s_waitcnt lgkmcnt(12)
    v_mfma_f32_16x16x32_bf16 v[88:91], v[212:215], v[160:163], v[88:91]
    ds_read_b128 v[184:187], v8 offset:20480
    v_max3_f32 v26, v137, v138, v26
    v_mfma_f32_16x16x32_bf16 v[92:95], v[212:215], v[164:167], v[92:95]
    ds_read_b128 v[188:191], v9 offset:20480
    v_max_f32 v26, v139, v26
    s_waitcnt lgkmcnt(12)
    v_mfma_f32_16x16x32_bf16 v[96:99], v[216:219], v[160:163], v[96:99]
    ds_read_b128 v[192:195], v10 offset:20480
    v_max3_f32 v27, v132, v133, v134
    v_mfma_f32_16x16x32_bf16 v[100:103], v[216:219], v[164:167], v[100:103]
    ds_read_b128 v[196:199], v11 offset:20480
    v_max3_f32 v27, v135, v140, v27
    s_waitcnt lgkmcnt(12)
    v_mfma_f32_16x16x32_bf16 v[104:107], v[220:223], v[160:163], v[104:107]
    v_max3_f32 v27, v141, v142, v27
    v_mfma_f32_16x16x32_bf16 v[108:111], v[220:223], v[164:167], v[108:111]
    v_max_f32 v27, v143, v27
    s_waitcnt lgkmcnt(10)
    v_mfma_f32_16x16x32_bf16 v[112:115], v[224:227], v[160:163], v[112:115]
    v_max_f32 v30, v26, v27
    v_mfma_f32_16x16x32_bf16 v[116:119], v[224:227], v[164:167], v[116:119]
    v_cmp_lt_f32 vcc, 0x41000000, v30
    s_waitcnt lgkmcnt(8)
    v_mfma_f32_16x16x32_bf16 v[120:123], v[228:231], v[160:163], v[120:123]
    v_mfma_f32_16x16x32_bf16 v[124:127], v[228:231], v[164:167], v[124:127]
    s_add_u32 s61, s61, 1
    s_cbranch_vccnz L_resc_l5
L_back_l5:
    s_cmp_lt_u32 s61, 25
    s_cbranch_scc1 L_loop
    s_waitcnt vmcnt(4) lgkmcnt(0)
    s_barrier
    v_mfma_f32_16x16x32_bf16 v[144:147], v[168:171], v[32:35], v[240:243]
    s_add_u32 s64, s68, 16384
    s_mov_b32 m0, s64
    s_nop 0
    buffer_load_dwordx4 v2, s[20:23], s59 offen nt lds
    ds_read_b64_tr_b16 v[200:201], v16 offset:32768
    v_exp_f32 v128, v128
    v_mfma_f32_16x16x32_bf16 v[144:147], v[172:175], v[36:39], v[144:147]
    ds_read_b64_tr_b16 v[202:203], v16 offset:36864
    v_exp_f32 v129, v129
    v_mfma_f32_16x16x32_bf16 v[144:147], v[176:179], v[40:43], v[144:147]
    buffer_load_dwordx4 v3, s[20:23], s59 offen offset:1024 nt lds
    s_add_u32 s59, s59, 16384
    ds_read_b64_tr_b16 v[204:205], v17 offset:32768
    v_exp_f32 v130, v130
    v_mfma_f32_16x16x32_bf16 v[144:147], v[180:183], v[44:47], v[144:147]
    ds_read_b64_tr_b16 v[206:207], v17 offset:36864
    v_cvt_pk_bf16_f32 v160, v128, v129
    v_exp_f32 v131, v131
    v_mfma_f32_16x16x32_bf16 v[148:151], v[168:171], v[48:51], v[244:247]
    s_add_u32 s64, s68, 65536
    s_mov_b32 m0, s64
    s_nop 0
    buffer_load_dwordx4 v4, s[24:27], s60 offen nt lds
    ds_read_b64_tr_b16 v[208:209], v18 offset:32768
    v_exp_f32 v136, v136
    v_mfma_f32_16x16x32_bf16 v[148:151], v[172:175], v[52:55], v[148:151]
    ds_read_b64_tr_b16 v[210:211], v18 offset:36864
    v_cvt_pk_bf16_f32 v161, v130, v131
    v_exp_f32 v137, v137
    v_mfma_f32_16x16x32_bf16 v[148:151], v[176:179], v[56:59], v[148:151]
    buffer_load_dwordx4 v5, s[24:27], s60 offen offset:1024 nt lds
    s_add_u32 s60, s60, 16384
    ds_read_b64_tr_b16 v[212:213], v19 offset:32768
    v_exp_f32 v138, v138
    v_mfma_f32_16x16x32_bf16 v[148:151], v[180:183], v[60:63], v[148:151]
    ds_read_b64_tr_b16 v[214:215], v19 offset:36864
    v_cvt_pk_bf16_f32 v162, v136, v137
    v_exp_f32 v139, v139
    v_mfma_f32_16x16x32_bf16 v[152:155], v[184:187], v[32:35], v[240:243]
    ds_read_b64_tr_b16 v[216:217], v20 offset:32768
    v_exp_f32 v132, v132
    v_mfma_f32_16x16x32_bf16 v[152:155], v[188:191], v[36:39], v[152:155]
    ds_read_b64_tr_b16 v[218:219], v20 offset:36864
    v_cvt_pk_bf16_f32 v163, v138, v139
    v_exp_f32 v133, v133
    v_mfma_f32_16x16x32_bf16 v[152:155], v[192:195], v[40:43], v[152:155]
    ds_read_b64_tr_b16 v[220:221], v21 offset:32768
    v_exp_f32 v134, v134
    v_mfma_f32_16x16x32_bf16 v[152:155], v[196:199], v[44:47], v[152:155]
    ds_read_b64_tr_b16 v[222:223], v21 offset:36864
    v_cvt_pk_bf16_f32 v164, v132, v133
    v_exp_f32 v135, v135
    v_mfma_f32_16x16x32_bf16 v[156:159], v[184:187], v[48:51], v[244:247]
    ds_read_b64_tr_b16 v[224:225], v22 offset:32768
    v_exp_f32 v140, v140
    v_mfma_f32_16x16x32_bf16 v[156:159], v[188:191], v[52:55], v[156:159]
    ds_read_b64_tr_b16 v[226:227], v22 offset:36864
    v_cvt_pk_bf16_f32 v165, v134, v135
    v_exp_f32 v141, v141
    v_mfma_f32_16x16x32_bf16 v[156:159], v[192:195], v[56:59], v[156:159]
    ds_read_b64_tr_b16 v[228:229], v23 offset:32768
    v_exp_f32 v142, v142
    v_mfma_f32_16x16x32_bf16 v[156:159], v[196:199], v[60:63], v[156:159]
    s_waitcnt lgkmcnt(14)
    ds_read_b64_tr_b16 v[230:231], v23 offset:36864
    v_cvt_pk_bf16_f32 v166, v140, v141
    v_exp_f32 v143, v143
    s_nop 0
    v_cvt_pk_bf16_f32 v167, v142, v143
    s_nop 1
    v_mfma_f32_16x16x32_bf16 v[248:251], v[12:15], v[160:163], v[248:251]
    v_mfma_f32_16x16x32_bf16 v[252:255], v[12:15], v[164:167], v[252:255]
    s_waitcnt lgkmcnt(14)
    v_mfma_f32_16x16x32_bf16 v[64:67], v[200:203], v[160:163], v[64:67]
    v_mfma_f32_16x16x32_bf16 v[68:71], v[200:203], v[164:167], v[68:71]
    s_waitcnt lgkmcnt(12)
    v_mfma_f32_16x16x32_bf16 v[72:75], v[204:207], v[160:163], v[72:75]
    ds_read_b128 v[168:171], v8 offset:32768
    v_mfma_f32_16x16x32_bf16 v[76:79], v[204:207], v[164:167], v[76:79]
    ds_read_b128 v[172:175], v9 offset:32768
    s_waitcnt lgkmcnt(12)
    v_mfma_f32_16x16x32_bf16 v[80:83], v[208:211], v[160:163], v[80:83]
    ds_read_b128 v[176:179], v10 offset:32768
    v_max3_f32 v26, v144, v145, v146
    v_mfma_f32_16x16x32_bf16 v[84:87], v[208:211], v[164:167], v[84:87]
    ds_read_b128 v[180:183], v11 offset:32768
    v_max3_f32 v26, v147, v152, v26
    s_waitcnt lgkmcnt(12)
    v_mfma_f32_16x16x32_bf16 v[88:91], v[212:215], v[160:163], v[88:91]
    ds_read_b128 v[184:187], v8 offset:36864
    v_max3_f32 v26, v153, v154, v26
    v_mfma_f32_16x16x32_bf16 v[92:95], v[212:215], v[164:167], v[92:95]
    ds_read_b128 v[188:191], v9 offset:36864
    v_max_f32 v26, v155, v26
    s_waitcnt lgkmcnt(12)
    v_mfma_f32_16x16x32_bf16 v[96:99], v[216:219], v[160:163], v[96:99]
    ds_read_b128 v[192:195], v10 offset:36864
    v_max3_f32 v27, v148, v149, v150
    v_mfma_f32_16x16x32_bf16 v[100:103], v[216:219], v[164:167], v[100:103]
    ds_read_b128 v[196:199], v11 offset:36864
    v_max3_f32 v27, v151, v156, v27
    s_waitcnt lgkmcnt(12)
    v_mfma_f32_16x16x32_bf16 v[104:107], v[220:223], v[160:163], v[104:107]
    v_max3_f32 v27, v157, v158, v27
    v_mfma_f32_16x16x32_bf16 v[108:111], v[220:223], v[164:167], v[108:111]
    v_max_f32 v27, v159, v27
    s_waitcnt lgkmcnt(10)
    v_mfma_f32_16x16x32_bf16 v[112:115], v[224:227], v[160:163], v[112:115]
    v_max_f32 v30, v26, v27
    v_mfma_f32_16x16x32_bf16 v[116:119], v[224:227], v[164:167], v[116:119]
    v_cmp_lt_f32 vcc, 0x41000000, v30
    s_waitcnt lgkmcnt(8)
    v_mfma_f32_16x16x32_bf16 v[120:123], v[228:231], v[160:163], v[120:123]
    v_mfma_f32_16x16x32_bf16 v[124:127], v[228:231], v[164:167], v[124:127]
    s_add_u32 s64, s78, 98304
    s_mov_b32 m0, s64
    s_lshl_b32 s65, s84, 15
    s_add_u32 s65, s65, 0
    s_and_b32 s65, s65, 0x7ffff
    buffer_load_dwordx4 v236, s[40:43], s65 offen lds
    buffer_load_dwordx4 v237, s[40:43], s65 offen offset:1024 lds
    s_lshl_b32 s64, s55, 21
    s_add_u32 s64, s64, 1114112
    v_mov_b32 v28, s64
    global_load_dword v232, v28, s[18:19]
    s_add_u32 s61, s61, 1
    s_cbranch_vccnz L_resc_p25
L_back_p25:
    s_waitcnt vmcnt(7) lgkmcnt(0)
    s_barrier
    v_mfma_f32_16x16x32_bf16 v[128:131], v[168:171], v[32:35], v[240:243]
    s_add_u32 s64, s68, 32768
    s_mov_b32 m0, s64
    s_nop 0
    buffer_load_dwordx4 v2, s[20:23], s59 offen nt lds
    ds_read_b64_tr_b16 v[200:201], v16 offset:0
    v_exp_f32 v144, v144
    v_mfma_f32_16x16x32_bf16 v[128:131], v[172:175], v[36:39], v[128:131]
    ds_read_b64_tr_b16 v[202:203], v16 offset:4096
    v_exp_f32 v145, v145
    v_mfma_f32_16x16x32_bf16 v[128:131], v[176:179], v[40:43], v[128:131]
    buffer_load_dwordx4 v3, s[20:23], s59 offen offset:1024 nt lds
    s_add_u32 s59, s59, 16384
    ds_read_b64_tr_b16 v[204:205], v17 offset:0
    v_exp_f32 v146, v146
    v_mfma_f32_16x16x32_bf16 v[128:131], v[180:183], v[44:47], v[128:131]
    ds_read_b64_tr_b16 v[206:207], v17 offset:4096
    v_cvt_pk_bf16_f32 v160, v144, v145
    v_exp_f32 v147, v147
    v_mfma_f32_16x16x32_bf16 v[132:135], v[168:171], v[48:51], v[244:247]
    s_add_u32 s64, s68, 81920
    s_mov_b32 m0, s64
    s_nop 0
    buffer_load_dwordx4 v4, s[24:27], s60 offen nt lds
    ds_read_b64_tr_b16 v[208:209], v18 offset:0
    v_exp_f32 v152, v152
    v_mfma_f32_16x16x32_bf16 v[132:135], v[172:175], v[52:55], v[132:135]
    ds_read_b64_tr_b16 v[210:211], v18 offset:4096
    v_cvt_pk_bf16_f32 v161, v146, v147
    v_exp_f32 v153, v153
    v_mfma_f32_16x16x32_bf16 v[132:135], v[176:179], v[56:59], v[132:135]
    buffer_load_dwordx4 v5, s[24:27], s60 offen offset:1024 nt lds
    s_add_u32 s60, s60, 16384
    ds_read_b64_tr_b16 v[212:213], v19 offset:0
    v_exp_f32 v154, v154
    v_mfma_f32_16x16x32_bf16 v[132:135], v[180:183], v[60:63], v[132:135]
    ds_read_b64_tr_b16 v[214:215], v19 offset:4096
    v_cvt_pk_bf16_f32 v162, v152, v153
    v_exp_f32 v155, v155
    v_mfma_f32_16x16x32_bf16 v[136:139], v[184:187], v[32:35], v[240:243]
    ds_read_b64_tr_b16 v[216:217], v20 offset:0
    v_exp_f32 v148, v148
    v_mfma_f32_16x16x32_bf16 v[136:139], v[188:191], v[36:39], v[136:139]
    ds_read_b64_tr_b16 v[218:219], v20 offset:4096
    v_cvt_pk_bf16_f32 v163, v154, v155
    v_exp_f32 v149, v149
    v_mfma_f32_16x16x32_bf16 v[136:139], v[192:195], v[40:43], v[136:139]
    ds_read_b64_tr_b16 v[220:221], v21 offset:0
    v_exp_f32 v150, v150
    v_mfma_f32_16x16x32_bf16 v[136:139], v[196:199], v[44:47], v[136:139]
    ds_read_b64_tr_b16 v[222:223], v21 offset:4096
    v_cvt_pk_bf16_f32 v164, v148, v149
    v_exp_f32 v151, v151
    v_mfma_f32_16x16x32_bf16 v[140:143], v[184:187], v[48:51], v[244:247]
    ds_read_b64_tr_b16 v[224:225], v22 offset:0
    v_exp_f32 v156, v156
    v_mfma_f32_16x16x32_bf16 v[140:143], v[188:191], v[52:55], v[140:143]
    ds_read_b64_tr_b16 v[226:227], v22 offset:4096
    v_cvt_pk_bf16_f32 v165, v150, v151
    v_exp_f32 v157, v157
    v_mfma_f32_16x16x32_bf16 v[140:143], v[192:195], v[56:59], v[140:143]
    ds_read_b64_tr_b16 v[228:229], v23 offset:0
    v_exp_f32 v158, v158
    v_mfma_f32_16x16x32_bf16 v[140:143], v[196:199], v[60:63], v[140:143]
    s_waitcnt lgkmcnt(14)
    ds_read_b64_tr_b16 v[230:231], v23 offset:4096
    v_cvt_pk_bf16_f32 v166, v156, v157
    v_exp_f32 v159, v159
    s_nop 0
    v_cvt_pk_bf16_f32 v167, v158, v159
    s_nop 1
    v_mfma_f32_16x16x32_bf16 v[248:251], v[12:15], v[160:163], v[248:251]
    v_mfma_f32_16x16x32_bf16 v[252:255], v[12:15], v[164:167], v[252:255]
    s_waitcnt lgkmcnt(14)
    v_mfma_f32_16x16x32_bf16 v[64:67], v[200:203], v[160:163], v[64:67]
    v_mfma_f32_16x16x32_bf16 v[68:71], v[200:203], v[164:167], v[68:71]
    s_waitcnt lgkmcnt(12)
    v_mfma_f32_16x16x32_bf16 v[72:75], v[204:207], v[160:163], v[72:75]
    ds_read_b128 v[168:171], v8 offset:0
    v_mfma_f32_16x16x32_bf16 v[76:79], v[204:207], v[164:167], v[76:79]
    ds_read_b128 v[172:175], v9 offset:0
    s_waitcnt lgkmcnt(12)
    v_mfma_f32_16x16x32_bf16 v[80:83], v[208:211], v[160:163], v[80:83]
    ds_read_b128 v[176:179], v10 offset:0
    v_max3_f32 v26, v128, v129, v130
    v_mfma_f32_16x16x32_bf16 v[84:87], v[208:211], v[164:167], v[84:87]
    ds_read_b128 v[180:183], v11 offset:0
    v_max3_f32 v26, v131, v136, v26
    s_waitcnt lgkmcnt(12)
    v_mfma_f32_16x16x32_bf16 v[88:91], v[212:215], v[160:163], v[88:91]
    ds_read_b128 v[184:187], v8 offset:4096
    v_max3_f32 v26, v137, v138, v26
    v_mfma_f32_16x16x32_bf16 v[92:95], v[212:215], v[164:167], v[92:95]
    ds_read_b128 v[188:191], v9 offset:4096
    v_max_f32 v26, v139, v26
    s_waitcnt lgkmcnt(12)
    v_mfma_f32_16x16x32_bf16 v[96:99], v[216:219], v[160:163], v[96:99]
    ds_read_b128 v[192:195], v10 offset:4096
    v_max3_f32 v27, v132, v133, v134
    v_mfma_f32_16x16x32_bf16 v[100:103], v[216:219], v[164:167], v[100:103]
    ds_read_b128 v[196:199], v11 offset:4096
    v_max3_f32 v27, v135, v140, v27
    s_waitcnt lgkmcnt(12)
    v_mfma_f32_16x16x32_bf16 v[104:107], v[220:223], v[160:163], v[104:107]
    v_max3_f32 v27, v141, v142, v27
    v_mfma_f32_16x16x32_bf16 v[108:111], v[220:223], v[164:167], v[108:111]
    v_max_f32 v27, v143, v27
    s_waitcnt lgkmcnt(10)
    v_mfma_f32_16x16x32_bf16 v[112:115], v[224:227], v[160:163], v[112:115]
    v_max_f32 v30, v26, v27
    v_mfma_f32_16x16x32_bf16 v[116:119], v[224:227], v[164:167], v[116:119]
    v_cmp_lt_f32 vcc, 0x41000000, v30
    s_waitcnt lgkmcnt(8)
    v_mfma_f32_16x16x32_bf16 v[120:123], v[228:231], v[160:163], v[120:123]
    v_mfma_f32_16x16x32_bf16 v[124:127], v[228:231], v[164:167], v[124:127]
    s_add_u32 s64, s78, 98304
    s_mov_b32 m0, s64
    s_lshl_b32 s65, s84, 15
    s_add_u32 s65, s65, 0
    s_and_b32 s65, s65, 0x7ffff
    buffer_load_dwordx4 v238, s[40:43], s65 offen offset:2048 lds
    buffer_load_dwordx4 v239, s[40:43], s65 offen offset:3072 lds
    s_lshl_b32 s64, s69, 21
    s_add_u32 s64, s64, 1114112
    v_mov_b32 v28, s64
    global_load_dword v232, v28, s[18:19]
    s_add_u32 s61, s61, 1
    s_cbranch_vccnz L_resc_p26
L_back_p26:
    s_waitcnt vmcnt(10) lgkmcnt(0)
    s_barrier
    v_mfma_f32_16x16x32_bf16 v[144:147], v[168:171], v[32:35], v[240:243]
    s_add_u32 s64, s68, 0
    s_mov_b32 m0, s64
    s_nop 0
    buffer_load_dwordx4 v2, s[20:23], s59 offen nt lds
    ds_read_b64_tr_b16 v[200:201], v16 offset:16384
    v_exp_f32 v128, v128
    v_mfma_f32_16x16x32_bf16 v[144:147], v[172:175], v[36:39], v[144:147]
    ds_read_b64_tr_b16 v[202:203], v16 offset:20480
    v_exp_f32 v129, v129
    v_mfma_f32_16x16x32_bf16 v[144:147], v[176:179], v[40:43], v[144:147]
    buffer_load_dwordx4 v3, s[20:23], s59 offen offset:1024 nt lds
    s_add_u32 s59, s59, 16384
    ds_read_b64_tr_b16 v[204:205], v17 offset:16384
    v_exp_f32 v130, v130
    v_mfma_f32_16x16x32_bf16 v[144:147], v[180:183], v[44:47], v[144:147]
    ds_read_b64_tr_b16 v[206:207], v17 offset:20480
    v_cvt_pk_bf16_f32 v160, v128, v129
    v_exp_f32 v131, v131
    v_mfma_f32_16x16x32_bf16 v[148:151], v[168:171], v[48:51], v[244:247]
    s_add_u32 s64, s68, 49152
    s_mov_b32 m0, s64
    s_nop 0
    buffer_load_dwordx4 v4, s[24:27], s60 offen nt lds
    ds_read_b64_tr_b16 v[208:209], v18 offset:16384
    v_exp_f32 v136, v136
    v_mfma_f32_16x16x32_bf16 v[148:151], v[172:175], v[52:55], v[148:151]
    ds_read_b64_tr_b16 v[210:211], v18 offset:20480
    v_cvt_pk_bf16_f32 v161, v130, v131
    v_exp_f32 v137, v137
    v_mfma_f32_16x16x32_bf16 v[148:151], v[176:179], v[56:59], v[148:151]
    buffer_load_dwordx4 v5, s[24:27], s60 offen offset:1024 nt lds
    s_add_u32 s60, s60, 16384
    ds_read_b64_tr_b16 v[212:213], v19 offset:16384
    v_exp_f32 v138, v138
    v_mfma_f32_16x16x32_bf16 v[148:151], v[180:183], v[60:63], v[148:151]
    ds_read_b64_tr_b16 v[214:215], v19 offset:20480
    v_cvt_pk_bf16_f32 v162, v136, v137
    v_exp_f32 v139, v139
    v_mfma_f32_16x16x32_bf16 v[152:155], v[184:187], v[32:35], v[240:243]
    ds_read_b64_tr_b16 v[216:217], v20 offset:16384
    v_exp_f32 v132, v132
    v_mfma_f32_16x16x32_bf16 v[152:155], v[188:191], v[36:39], v[152:155]
    ds_read_b64_tr_b16 v[218:219], v20 offset:20480
    v_cvt_pk_bf16_f32 v163, v138, v139
    v_exp_f32 v133, v133
    v_mfma_f32_16x16x32_bf16 v[152:155], v[192:195], v[40:43], v[152:155]
    ds_read_b64_tr_b16 v[220:221], v21 offset:16384
    v_exp_f32 v134, v134
    v_mfma_f32_16x16x32_bf16 v[152:155], v[196:199], v[44:47], v[152:155]
    ds_read_b64_tr_b16 v[222:223], v21 offset:20480
    v_cvt_pk_bf16_f32 v164, v132, v133
    v_exp_f32 v135, v135
    v_mfma_f32_16x16x32_bf16 v[156:159], v[184:187], v[48:51], v[244:247]
    ds_read_b64_tr_b16 v[224:225], v22 offset:16384
    v_exp_f32 v140, v140
    v_mfma_f32_16x16x32_bf16 v[156:159], v[188:191], v[52:55], v[156:159]
    ds_read_b64_tr_b16 v[226:227], v22 offset:20480
    v_cvt_pk_bf16_f32 v165, v134, v135
    v_exp_f32 v141, v141
    v_mfma_f32_16x16x32_bf16 v[156:159], v[192:195], v[56:59], v[156:159]
    ds_read_b64_tr_b16 v[228:229], v23 offset:16384
    v_exp_f32 v142, v142
    v_mfma_f32_16x16x32_bf16 v[156:159], v[196:199], v[60:63], v[156:159]
    s_waitcnt lgkmcnt(14)
    ds_read_b64_tr_b16 v[230:231], v23 offset:20480
    v_cvt_pk_bf16_f32 v166, v140, v141
    v_exp_f32 v143, v143
    s_nop 0
    v_cvt_pk_bf16_f32 v167, v142, v143
    s_nop 1
    v_mfma_f32_16x16x32_bf16 v[248:251], v[12:15], v[160:163], v[248:251]
    v_mfma_f32_16x16x32_bf16 v[252:255], v[12:15], v[164:167], v[252:255]
    s_waitcnt lgkmcnt(14)
    v_mfma_f32_16x16x32_bf16 v[64:67], v[200:203], v[160:163], v[64:67]
    v_mfma_f32_16x16x32_bf16 v[68:71], v[200:203], v[164:167], v[68:71]
    s_waitcnt lgkmcnt(12)
    v_mfma_f32_16x16x32_bf16 v[72:75], v[204:207], v[160:163], v[72:75]
    ds_read_b128 v[168:171], v8 offset:16384
    v_mfma_f32_16x16x32_bf16 v[76:79], v[204:207], v[164:167], v[76:79]
    ds_read_b128 v[172:175], v9 offset:16384
    s_waitcnt lgkmcnt(12)
    v_mfma_f32_16x16x32_bf16 v[80:83], v[208:211], v[160:163], v[80:83]
    ds_read_b128 v[176:179], v10 offset:16384
    v_max3_f32 v26, v144, v145, v146
    v_mfma_f32_16x16x32_bf16 v[84:87], v[208:211], v[164:167], v[84:87]
    ds_read_b128 v[180:183], v11 offset:16384
    v_max3_f32 v26, v147, v152, v26
    s_waitcnt lgkmcnt(12)
    v_mfma_f32_16x16x32_bf16 v[88:91], v[212:215], v[160:163], v[88:91]
    ds_read_b128 v[184:187], v8 offset:20480
    v_max3_f32 v26, v153, v154, v26
    v_mfma_f32_16x16x32_bf16 v[92:95], v[212:215], v[164:167], v[92:95]
    ds_read_b128 v[188:191], v9 offset:20480
    v_max_f32 v26, v155, v26
    s_waitcnt lgkmcnt(12)
    v_mfma_f32_16x16x32_bf16 v[96:99], v[216:219], v[160:163], v[96:99]
    ds_read_b128 v[192:195], v10 offset:20480
    v_max3_f32 v27, v148, v149, v150
    v_mfma_f32_16x16x32_bf16 v[100:103], v[216:219], v[164:167], v[100:103]
    ds_read_b128 v[196:199], v11 offset:20480
    v_max3_f32 v27, v151, v156, v27
    s_waitcnt lgkmcnt(12)
    v_mfma_f32_16x16x32_bf16 v[104:107], v[220:223], v[160:163], v[104:107]
    v_max3_f32 v27, v157, v158, v27
    v_mfma_f32_16x16x32_bf16 v[108:111], v[220:223], v[164:167], v[108:111]
    v_max_f32 v27, v159, v27
    s_waitcnt lgkmcnt(10)
    v_mfma_f32_16x16x32_bf16 v[112:115], v[224:227], v[160:163], v[112:115]
    v_max_f32 v30, v26, v27
    v_mfma_f32_16x16x32_bf16 v[116:119], v[224:227], v[164:167], v[116:119]
    v_cmp_lt_f32 vcc, 0x41000000, v30
    s_waitcnt lgkmcnt(8)
    v_mfma_f32_16x16x32_bf16 v[120:123], v[228:231], v[160:163], v[120:123]
    v_mfma_f32_16x16x32_bf16 v[124:127], v[228:231], v[164:167], v[124:127]
    s_add_u32 s64, s78, 131072
    s_mov_b32 m0, s64
    s_lshl_b32 s65, s84, 15
    s_add_u32 s65, s65, 32768
    s_and_b32 s65, s65, 0x7ffff
    buffer_load_dwordx4 v236, s[40:43], s65 offen lds
    buffer_load_dwordx4 v237, s[40:43], s65 offen offset:1024 lds
    v_mov_b32 v28, 0
    buffer_load_dword v232, v28, s[44:47], 0 offen
    s_add_u32 s61, s61, 1
    s_cbranch_vccnz L_resc_p27
L_back_p27:
    s_waitcnt vmcnt(10) lgkmcnt(0)
    s_barrier
    v_mfma_f32_16x16x32_bf16 v[128:131], v[168:171], v[32:35], v[240:243]
    s_add_u32 s64, s68, 16384
    s_mov_b32 m0, s64
    s_nop 0
    buffer_load_dwordx4 v2, s[20:23], s59 offen nt lds
    ds_read_b64_tr_b16 v[200:201], v16 offset:32768
    v_exp_f32 v144, v144
    v_mfma_f32_16x16x32_bf16 v[128:131], v[172:175], v[36:39], v[128:131]
    ds_read_b64_tr_b16 v[202:203], v16 offset:36864
    v_exp_f32 v145, v145
    v_mfma_f32_16x16x32_bf16 v[128:131], v[176:179], v[40:43], v[128:131]
    buffer_load_dwordx4 v3, s[20:23], s59 offen offset:1024 nt lds
    s_add_u32 s59, s59, 16384
    ds_read_b64_tr_b16 v[204:205], v17 offset:32768
    v_exp_f32 v146, v146
    v_mfma_f32_16x16x32_bf16 v[128:131], v[180:183], v[44:47], v[128:131]
    ds_read_b64_tr_b16 v[206:207], v17 offset:36864
    v_cvt_pk_bf16_f32 v160, v144, v145
    v_exp_f32 v147, v147
    v_mfma_f32_16x16x32_bf16 v[132:135], v[168:171], v[48:51], v[244:247]
    s_add_u32 s64, s68, 65536
    s_mov_b32 m0, s64
    s_nop 0
    buffer_load_dwordx4 v4, s[24:27], s60 offen nt lds
    ds_read_b64_tr_b16 v[208:209], v18 offset:32768
    v_exp_f32 v152, v152
    v_mfma_f32_16x16x32_bf16 v[132:135], v[172:175], v[52:55], v[132:135]
    ds_read_b64_tr_b16 v[210:211], v18 offset:36864
    v_cvt_pk_bf16_f32 v161, v146, v147
    v_exp_f32 v153, v153
    v_mfma_f32_16x16x32_bf16 v[132:135], v[176:179], v[56:59], v[132:135]
    buffer_load_dwordx4 v5, s[24:27], s60 offen offset:1024 nt lds
    s_add_u32 s60, s60, 16384
    ds_read_b64_tr_b16 v[212:213], v19 offset:32768
    v_exp_f32 v154, v154
    v_mfma_f32_16x16x32_bf16 v[132:135], v[180:183], v[60:63], v[132:135]
    ds_read_b64_tr_b16 v[214:215], v19 offset:36864
    v_cvt_pk_bf16_f32 v162, v152, v153
    v_exp_f32 v155, v155
    v_mfma_f32_16x16x32_bf16 v[136:139], v[184:187], v[32:35], v[240:243]
    ds_read_b64_tr_b16 v[216:217], v20 offset:32768
    v_exp_f32 v148, v148
    v_mfma_f32_16x16x32_bf16 v[136:139], v[188:191], v[36:39], v[136:139]
    ds_read_b64_tr_b16 v[218:219], v20 offset:36864
    v_cvt_pk_bf16_f32 v163, v154, v155
    v_exp_f32 v149, v149
    v_mfma_f32_16x16x32_bf16 v[136:139], v[192:195], v[40:43], v[136:139]
    ds_read_b64_tr_b16 v[220:221], v21 offset:32768
    v_exp_f32 v150, v150
    v_mfma_f32_16x16x32_bf16 v[136:139], v[196:199], v[44:47], v[136:139]
    ds_read_b64_tr_b16 v[222:223], v21 offset:36864
    v_cvt_pk_bf16_f32 v164, v148, v149
    v_exp_f32 v151, v151
    v_mfma_f32_16x16x32_bf16 v[140:143], v[184:187], v[48:51], v[244:247]
    ds_read_b64_tr_b16 v[224:225], v22 offset:32768
    v_exp_f32 v156, v156
    v_mfma_f32_16x16x32_bf16 v[140:143], v[188:191], v[52:55], v[140:143]
    ds_read_b64_tr_b16 v[226:227], v22 offset:36864
    v_cvt_pk_bf16_f32 v165, v150, v151
    v_exp_f32 v157, v157
    v_mfma_f32_16x16x32_bf16 v[140:143], v[192:195], v[56:59], v[140:143]
    ds_read_b64_tr_b16 v[228:229], v23 offset:32768
    v_exp_f32 v158, v158
    v_mfma_f32_16x16x32_bf16 v[140:143], v[196:199], v[60:63], v[140:143]
    s_waitcnt lgkmcnt(14)
    ds_read_b64_tr_b16 v[230:231], v23 offset:36864
    v_cvt_pk_bf16_f32 v166, v156, v157
    v_exp_f32 v159, v159
    s_nop 0
    v_cvt_pk_bf16_f32 v167, v158, v159
    s_nop 1
    v_mfma_f32_16x16x32_bf16 v[248:251], v[12:15], v[160:163], v[248:251]
    v_mfma_f32_16x16x32_bf16 v[252:255], v[12:15], v[164:167], v[252:255]
    s_waitcnt lgkmcnt(14)
    v_mfma_f32_16x16x32_bf16 v[64:67], v[200:203], v[160:163], v[64:67]
    v_mfma_f32_16x16x32_bf16 v[68:71], v[200:203], v[164:167], v[68:71]
    s_waitcnt lgkmcnt(12)
    v_mfma_f32_16x16x32_bf16 v[72:75], v[204:207], v[160:163], v[72:75]
    ds_read_b128 v[168:171], v8 offset:32768
    v_mfma_f32_16x16x32_bf16 v[76:79], v[204:207], v[164:167], v[76:79]
    ds_read_b128 v[172:175], v9 offset:32768
    s_waitcnt lgkmcnt(12)
    v_mfma_f32_16x16x32_bf16 v[80:83], v[208:211], v[160:163], v[80:83]
    ds_read_b128 v[176:179], v10 offset:32768
    v_max3_f32 v26, v128, v129, v130
    v_mfma_f32_16x16x32_bf16 v[84:87], v[208:211], v[164:167], v[84:87]
    ds_read_b128 v[180:183], v11 offset:32768
    v_max3_f32 v26, v131, v136, v26
    s_waitcnt lgkmcnt(12)
    v_mfma_f32_16x16x32_bf16 v[88:91], v[212:215], v[160:163], v[88:91]
    ds_read_b128 v[184:187], v8 offset:36864
    v_max3_f32 v26, v137, v138, v26
    v_mfma_f32_16x16x32_bf16 v[92:95], v[212:215], v[164:167], v[92:95]
    ds_read_b128 v[188:191], v9 offset:36864
    v_max_f32 v26, v139, v26
    s_waitcnt lgkmcnt(12)
    v_mfma_f32_16x16x32_bf16 v[96:99], v[216:219], v[160:163], v[96:99]
    ds_read_b128 v[192:195], v10 offset:36864
    v_max3_f32 v27, v132, v133, v134
    v_mfma_f32_16x16x32_bf16 v[100:103], v[216:219], v[164:167], v[100:103]
    ds_read_b128 v[196:199], v11 offset:36864
    v_max3_f32 v27, v135, v140, v27
    s_waitcnt lgkmcnt(12)
    v_mfma_f32_16x16x32_bf16 v[104:107], v[220:223], v[160:163], v[104:107]
    v_max3_f32 v27, v141, v142, v27
    v_mfma_f32_16x16x32_bf16 v[108:111], v[220:223], v[164:167], v[108:111]
    v_max_f32 v27, v143, v27
    s_waitcnt lgkmcnt(10)
    v_mfma_f32_16x16x32_bf16 v[112:115], v[224:227], v[160:163], v[112:115]
    v_max_f32 v30, v26, v27
    v_mfma_f32_16x16x32_bf16 v[116:119], v[224:227], v[164:167], v[116:119]
    v_cmp_lt_f32 vcc, 0x41000000, v30
    s_waitcnt lgkmcnt(8)
    v_mfma_f32_16x16x32_bf16 v[120:123], v[228:231], v[160:163], v[120:123]
    v_mfma_f32_16x16x32_bf16 v[124:127], v[228:231], v[164:167], v[124:127]
    s_add_u32 s64, s78, 131072
    s_mov_b32 m0, s64
    s_lshl_b32 s65, s84, 15
    s_add_u32 s65, s65, 32768
    s_and_b32 s65, s65, 0x7ffff
    buffer_load_dwordx4 v238, s[40:43], s65 offen offset:2048 lds
    buffer_load_dwordx4 v239, s[40:43], s65 offen offset:3072 lds
    v_mov_b32 v28, 0
    buffer_load_dword v232, v28, s[48:51], 0 offen sc1
    s_add_u32 s61, s61, 1
    s_cbranch_vccnz L_resc_p28
L_back_p28:
    s_waitcnt vmcnt(10) lgkmcnt(0)
    s_barrier
    v_mfma_f32_16x16x32_bf16 v[144:147], v[168:171], v[32:35], v[240:243]
    s_add_u32 s64, s68, 81920
    s_mov_b32 m0, s64
    s_nop 0
    buffer_load_dwordx4 v4, s[24:27], s60 offen nt lds
    ds_read_b64_tr_b16 v[200:201], v16 offset:0
    v_exp_f32 v128, v128
    v_mfma_f32_16x16x32_bf16 v[144:147], v[172:175], v[36:39], v[144:147]
    ds_read_b64_tr_b16 v[202:203], v16 offset:4096
    v_exp_f32 v129, v129
    v_mfma_f32_16x16x32_bf16 v[144:147], v[176:179], v[40:43], v[144:147]
    buffer_load_dwordx4 v5, s[24:27], s60 offen offset:1024 nt lds
    s_add_u32 s60, s60, 16384
    ds_read_b64_tr_b16 v[204:205], v17 offset:0
    v_exp_f32 v130, v130
    v_mfma_f32_16x16x32_bf16 v[144:147], v[180:183], v[44:47], v[144:147]
    ds_read_b64_tr_b16 v[206:207], v17 offset:4096
    v_cvt_pk_bf16_f32 v160, v128, v129
    v_exp_f32 v131, v131
    v_mfma_f32_16x16x32_bf16 v[148:151], v[168:171], v[48:51], v[244:247]
    ds_read_b64_tr_b16 v[208:209], v18 offset:0
    v_exp_f32 v136, v136
    v_mfma_f32_16x16x32_bf16 v[148:151], v[172:175], v[52:55], v[148:151]
    ds_read_b64_tr_b16 v[210:211], v18 offset:4096
    v_cvt_pk_bf16_f32 v161, v130, v131
    v_exp_f32 v137, v137
    v_mfma_f32_16x16x32_bf16 v[148:151], v[176:179], v[56:59], v[148:151]
    ds_read_b64_tr_b16 v[212:213], v19 offset:0
    v_exp_f32 v138, v138
    v_mfma_f32_16x16x32_bf16 v[148:151], v[180:183], v[60:63], v[148:151]
    ds_read_b64_tr_b16 v[214:215], v19 offset:4096
    v_cvt_pk_bf16_f32 v162, v136, v137
    v_exp_f32 v139, v139
    v_mfma_f32_16x16x32_bf16 v[152:155], v[184:187], v[32:35], v[240:243]
    ds_read_b64_tr_b16 v[216:217], v20 offset:0
    v_exp_f32 v132, v132
    v_mfma_f32_16x16x32_bf16 v[152:155], v[188:191], v[36:39], v[152:155]
    ds_read_b64_tr_b16 v[218:219], v20 offset:4096
    v_cvt_pk_bf16_f32 v163, v138, v139
    v_exp_f32 v133, v133
    v_mfma_f32_16x16x32_bf16 v[152:155], v[192:195], v[40:43], v[152:155]
    ds_read_b64_tr_b16 v[220:221], v21 offset:0
    v_exp_f32 v134, v134
    v_mfma_f32_16x16x32_bf16 v[152:155], v[196:199], v[44:47], v[152:155]
    ds_read_b64_tr_b16 v[222:223], v21 offset:4096
    v_cvt_pk_bf16_f32 v164, v132, v133
    v_exp_f32 v135, v135
    v_mfma_f32_16x16x32_bf16 v[156:159], v[184:187], v[48:51], v[244:247]
    ds_read_b64_tr_b16 v[224:225], v22 offset:0
    v_exp_f32 v140, v140
    v_mfma_f32_16x16x32_bf16 v[156:159], v[188:191], v[52:55], v[156:159]
    ds_read_b64_tr_b16 v[226:227], v22 offset:4096
    v_cvt_pk_bf16_f32 v165, v134, v135
    v_exp_f32 v141, v141
    v_mfma_f32_16x16x32_bf16 v[156:159], v[192:195], v[56:59], v[156:159]
    ds_read_b64_tr_b16 v[228:229], v23 offset:0
    v_exp_f32 v142, v142
    v_mfma_f32_16x16x32_bf16 v[156:159], v[196:199], v[60:63], v[156:159]
    s_waitcnt lgkmcnt(14)
    ds_read_b64_tr_b16 v[230:231], v23 offset:4096
    v_cvt_pk_bf16_f32 v166, v140, v141
    v_exp_f32 v143, v143
    s_nop 0
    v_cvt_pk_bf16_f32 v167, v142, v143
    s_nop 1
    v_mfma_f32_16x16x32_bf16 v[248:251], v[12:15], v[160:163], v[248:251]
    v_mfma_f32_16x16x32_bf16 v[252:255], v[12:15], v[164:167], v[252:255]
    s_waitcnt lgkmcnt(14)
    v_mfma_f32_16x16x32_bf16 v[64:67], v[200:203], v[160:163], v[64:67]
    v_mfma_f32_16x16x32_bf16 v[68:71], v[200:203], v[164:167], v[68:71]
    s_waitcnt lgkmcnt(12)
    v_mfma_f32_16x16x32_bf16 v[72:75], v[204:207], v[160:163], v[72:75]
    ds_read_b128 v[168:171], v8 offset:0
    v_mfma_f32_16x16x32_bf16 v[76:79], v[204:207], v[164:167], v[76:79]
    ds_read_b128 v[172:175], v9 offset:0
    s_waitcnt lgkmcnt(12)
    v_mfma_f32_16x16x32_bf16 v[80:83], v[208:211], v[160:163], v[80:83]
    ds_read_b128 v[176:179], v10 offset:0
    v_max3_f32 v26, v144, v145, v146
    v_mfma_f32_16x16x32_bf16 v[84:87], v[208:211], v[164:167], v[84:87]
    ds_read_b128 v[180:183], v11 offset:0
    v_max3_f32 v26, v147, v152, v26
    s_waitcnt lgkmcnt(12)
    v_mfma_f32_16x16x32_bf16 v[88:91], v[212:215], v[160:163], v[88:91]
    ds_read_b128 v[184:187], v8 offset:4096
    v_max3_f32 v26, v153, v154, v26
    v_mfma_f32_16x16x32_bf16 v[92:95], v[212:215], v[164:167], v[92:95]
    ds_read_b128 v[188:191], v9 offset:4096
    v_max_f32 v26, v155, v26
    s_waitcnt lgkmcnt(12)
    v_mfma_f32_16x16x32_bf16 v[96:99], v[216:219], v[160:163], v[96:99]
    ds_read_b128 v[192:195], v10 offset:4096
    v_max3_f32 v27, v148, v149, v150
    v_mfma_f32_16x16x32_bf16 v[100:103], v[216:219], v[164:167], v[100:103]
    ds_read_b128 v[196:199], v11 offset:4096
    v_max3_f32 v27, v151, v156, v27
    s_waitcnt lgkmcnt(12)
    v_mfma_f32_16x16x32_bf16 v[104:107], v[220:223], v[160:163], v[104:107]
    v_max3_f32 v27, v157, v158, v27
    v_mfma_f32_16x16x32_bf16 v[108:111], v[220:223], v[164:167], v[108:111]
    v_max_f32 v27, v159, v27
    s_waitcnt lgkmcnt(10)
    v_mfma_f32_16x16x32_bf16 v[112:115], v[224:227], v[160:163], v[112:115]
    v_max_f32 v30, v26, v27
    v_mfma_f32_16x16x32_bf16 v[116:119], v[224:227], v[164:167], v[116:119]
    v_cmp_lt_f32 vcc, 0x41000000, v30
    s_waitcnt lgkmcnt(8)
    v_mfma_f32_16x16x32_bf16 v[120:123], v[228:231], v[160:163], v[120:123]
    v_mfma_f32_16x16x32_bf16 v[124:127], v[228:231], v[164:167], v[124:127]
    s_add_u32 s61, s61, 1
    s_cbranch_vccnz L_resc_p29
L_back_p29:
    s_waitcnt vmcnt(5) lgkmcnt(0)
    s_barrier
    v_mfma_f32_16x16x32_bf16 v[128:131], v[168:171], v[32:35], v[240:243]
    s_add_u32 s64, s68, 49152
    s_mov_b32 m0, s64
    s_nop 0
    buffer_load_dwordx4 v4, s[24:27], s60 offen nt lds
    ds_read_b64_tr_b16 v[200:201], v16 offset:16384
    v_exp_f32 v144, v144
    v_mfma_f32_16x16x32_bf16 v[128:131], v[172:175], v[36:39], v[128:131]
    ds_read_b64_tr_b16 v[202:203], v16 offset:20480
    v_exp_f32 v145, v145
    v_mfma_f32_16x16x32_bf16 v[128:131], v[176:179], v[40:43], v[128:131]
    buffer_load_dwordx4 v5, s[24:27], s60 offen offset:1024 nt lds
    s_add_u32 s60, s60, 16384
    ds_read_b64_tr_b16 v[204:205], v17 offset:16384
    v_exp_f32 v146, v146
    v_mfma_f32_16x16x32_bf16 v[128:131], v[180:183], v[44:47], v[128:131]
    ds_read_b64_tr_b16 v[206:207], v17 offset:20480
    v_cvt_pk_bf16_f32 v160, v144, v145
    v_exp_f32 v147, v147
    v_mfma_f32_16x16x32_bf16 v[132:135], v[168:171], v[48:51], v[244:247]
    ds_read_b64_tr_b16 v[208:209], v18 offset:16384
    v_exp_f32 v152, v152
    v_mfma_f32_16x16x32_bf16 v[132:135], v[172:175], v[52:55], v[132:135]
    ds_read_b64_tr_b16 v[210:211], v18 offset:20480
    v_cvt_pk_bf16_f32 v161, v146, v147
    v_exp_f32 v153, v153
    v_mfma_f32_16x16x32_bf16 v[132:135], v[176:179], v[56:59], v[132:135]
    ds_read_b64_tr_b16 v[212:213], v19 offset:16384
    v_exp_f32 v154, v154
    v_mfma_f32_16x16x32_bf16 v[132:135], v[180:183], v[60:63], v[132:135]
    ds_read_b64_tr_b16 v[214:215], v19 offset:20480
    v_cvt_pk_bf16_f32 v162, v152, v153
    v_exp_f32 v155, v155
    v_mfma_f32_16x16x32_bf16 v[136:139], v[184:187], v[32:35], v[240:243]
    ds_read_b64_tr_b16 v[216:217], v20 offset:16384
    v_exp_f32 v148, v148
    v_mfma_f32_16x16x32_bf16 v[136:139], v[188:191], v[36:39], v[136:139]
    ds_read_b64_tr_b16 v[218:219], v20 offset:20480
    v_cvt_pk_bf16_f32 v163, v154, v155
    v_exp_f32 v149, v149
    v_mfma_f32_16x16x32_bf16 v[136:139], v[192:195], v[40:43], v[136:139]
    ds_read_b64_tr_b16 v[220:221], v21 offset:16384
    v_exp_f32 v150, v150
    v_mfma_f32_16x16x32_bf16 v[136:139], v[196:199], v[44:47], v[136:139]
    ds_read_b64_tr_b16 v[222:223], v21 offset:20480
    v_cvt_pk_bf16_f32 v164, v148, v149
    v_exp_f32 v151, v151
    v_mfma_f32_16x16x32_bf16 v[140:143], v[184:187], v[48:51], v[244:247]
    ds_read_b64_tr_b16 v[224:225], v22 offset:16384
    v_exp_f32 v156, v156
    v_mfma_f32_16x16x32_bf16 v[140:143], v[188:191], v[52:55], v[140:143]
    ds_read_b64_tr_b16 v[226:227], v22 offset:20480
    v_cvt_pk_bf16_f32 v165, v150, v151
    v_exp_f32 v157, v157
    v_mfma_f32_16x16x32_bf16 v[140:143], v[192:195], v[56:59], v[140:143]
    ds_read_b64_tr_b16 v[228:229], v23 offset:16384
    v_exp_f32 v158, v158
    v_mfma_f32_16x16x32_bf16 v[140:143], v[196:199], v[60:63], v[140:143]
    s_waitcnt lgkmcnt(14)
    ds_read_b64_tr_b16 v[230:231], v23 offset:20480
    v_cvt_pk_bf16_f32 v166, v156, v157
    v_exp_f32 v159, v159
    s_nop 0
    v_cvt_pk_bf16_f32 v167, v158, v159
    s_nop 1
    v_mfma_f32_16x16x32_bf16 v[248:251], v[12:15], v[160:163], v[248:251]
    v_mfma_f32_16x16x32_bf16 v[252:255], v[12:15], v[164:167], v[252:255]
    s_waitcnt lgkmcnt(14)
    v_mfma_f32_16x16x32_bf16 v[64:67], v[200:203], v[160:163], v[64:67]
    v_mfma_f32_16x16x32_bf16 v[68:71], v[200:203], v[164:167], v[68:71]
    s_waitcnt lgkmcnt(12)
    v_mfma_f32_16x16x32_bf16 v[72:75], v[204:207], v[160:163], v[72:75]
    ds_read_b128 v[168:171], v8 offset:16384
    v_mfma_f32_16x16x32_bf16 v[76:79], v[204:207], v[164:167], v[76:79]
    ds_read_b128 v[172:175], v9 offset:16384
    s_waitcnt lgkmcnt(12)
    v_mfma_f32_16x16x32_bf16 v[80:83], v[208:211], v[160:163], v[80:83]
    ds_read_b128 v[176:179], v10 offset:16384
    v_max3_f32 v26, v128, v129, v130
    v_mfma_f32_16x16x32_bf16 v[84:87], v[208:211], v[164:167], v[84:87]
    ds_read_b128 v[180:183], v11 offset:16384
    v_max3_f32 v26, v131, v136, v26
    s_waitcnt lgkmcnt(12)
    v_mfma_f32_16x16x32_bf16 v[88:91], v[212:215], v[160:163], v[88:91]
    ds_read_b128 v[184:187], v8 offset:20480
    v_max3_f32 v26, v137, v138, v26
    v_mfma_f32_16x16x32_bf16 v[92:95], v[212:215], v[164:167], v[92:95]
    ds_read_b128 v[188:191], v9 offset:20480
    v_max_f32 v26, v139, v26
    s_waitcnt lgkmcnt(12)
    v_mfma_f32_16x16x32_bf16 v[96:99], v[216:219], v[160:163], v[96:99]
    ds_read_b128 v[192:195], v10 offset:20480
    v_max3_f32 v27, v132, v133, v134
    v_mfma_f32_16x16x32_bf16 v[100:103], v[216:219], v[164:167], v[100:103]
    ds_read_b128 v[196:199], v11 offset:20480
    v_max3_f32 v27, v135, v140, v27
    s_waitcnt lgkmcnt(12)
    v_mfma_f32_16x16x32_bf16 v[104:107], v[220:223], v[160:163], v[104:107]
    v_max3_f32 v27, v141, v142, v27
    v_mfma_f32_16x16x32_bf16 v[108:111], v[220:223], v[164:167], v[108:111]
    v_max_f32 v27, v143, v27
    s_waitcnt lgkmcnt(10)
    v_mfma_f32_16x16x32_bf16 v[112:115], v[224:227], v[160:163], v[112:115]
    v_max_f32 v30, v26, v27
    v_mfma_f32_16x16x32_bf16 v[116:119], v[224:227], v[164:167], v[116:119]
    v_cmp_lt_f32 vcc, 0x41000000, v30
    s_waitcnt lgkmcnt(8)
    v_mfma_f32_16x16x32_bf16 v[120:123], v[228:231], v[160:163], v[120:123]
    v_mfma_f32_16x16x32_bf16 v[124:127], v[228:231], v[164:167], v[124:127]
    s_add_u32 s61, s61, 1
    s_cbranch_vccnz L_resc_p30
L_back_p30:
    s_waitcnt vmcnt(2) lgkmcnt(0)
    s_barrier
    v_mfma_f32_16x16x32_bf16 v[144:147], v[168:171], v[32:35], v[240:243]
    ds_read_b64_tr_b16 v[200:201], v16 offset:32768
    v_exp_f32 v128, v128
    v_mfma_f32_16x16x32_bf16 v[144:147], v[172:175], v[36:39], v[144:147]
    ds_read_b64_tr_b16 v[202:203], v16 offset:36864
    v_exp_f32 v129, v129
    v_mfma_f32_16x16x32_bf16 v[144:147], v[176:179], v[40:43], v[144:147]
    ds_read_b64_tr_b16 v[204:205], v17 offset:32768
    v_exp_f32 v130, v130
    v_mfma_f32_16x16x32_bf16 v[144:147], v[180:183], v[44:47], v[144:147]
    ds_read_b64_tr_b16 v[206:207], v17 offset:36864
    v_cvt_pk_bf16_f32 v160, v128, v129
    v_exp_f32 v131, v131
    v_mfma_f32_16x16x32_bf16 v[148:151], v[168:171], v[48:51], v[244:247]
    ds_read_b64_tr_b16 v[208:209], v18 offset:32768
    v_exp_f32 v136, v136
    v_mfma_f32_16x16x32_bf16 v[148:151], v[172:175], v[52:55], v[148:151]
    ds_read_b64_tr_b16 v[210:211], v18 offset:36864
    v_cvt_pk_bf16_f32 v161, v130, v131
    v_exp_f32 v137, v137
    v_mfma_f32_16x16x32_bf16 v[148:151], v[176:179], v[56:59], v[148:151]
    ds_read_b64_tr_b16 v[212:213], v19 offset:32768
    v_exp_f32 v138, v138
    v_mfma_f32_16x16x32_bf16 v[148:151], v[180:183], v[60:63], v[148:151]
    ds_read_b64_tr_b16 v[214:215], v19 offset:36864
    v_cvt_pk_bf16_f32 v162, v136, v137
    v_exp_f32 v139, v139
    v_mfma_f32_16x16x32_bf16 v[152:155], v[184:187], v[32:35], v[240:243]
    ds_read_b64_tr_b16 v[216:217], v20 offset:32768
    v_exp_f32 v132, v132
    v_mfma_f32_16x16x32_bf16 v[152:155], v[188:191], v[36:39], v[152:155]
    ds_read_b64_tr_b16 v[218:219], v20 offset:36864
    v_cvt_pk_bf16_f32 v163, v138, v139
    v_exp_f32 v133, v133
    v_mfma_f32_16x16x32_bf16 v[152:155], v[192:195], v[40:43], v[152:155]
    ds_read_b64_tr_b16 v[220:221], v21 offset:32768
    v_exp_f32 v134, v134
    v_mfma_f32_16x16x32_bf16 v[152:155], v[196:199], v[44:47], v[152:155]
    ds_read_b64_tr_b16 v[222:223], v21 offset:36864
    v_cvt_pk_bf16_f32 v164, v132, v133
    v_exp_f32 v135, v135
    v_mfma_f32_16x16x32_bf16 v[156:159], v[184:187], v[48:51], v[244:247]
    ds_read_b64_tr_b16 v[224:225], v22 offset:32768
    v_exp_f32 v140, v140
    v_mfma_f32_16x16x32_bf16 v[156:159], v[188:191], v[52:55], v[156:159]
    ds_read_b64_tr_b16 v[226:227], v22 offset:36864
    v_cvt_pk_bf16_f32 v165, v134, v135
    v_exp_f32 v141, v141
    v_mfma_f32_16x16x32_bf16 v[156:159], v[192:195], v[56:59], v[156:159]
    ds_read_b64_tr_b16 v[228:229], v23 offset:32768
    v_exp_f32 v142, v142
    v_mfma_f32_16x16x32_bf16 v[156:159], v[196:199], v[60:63], v[156:159]
    s_waitcnt lgkmcnt(14)
    ds_read_b64_tr_b16 v[230:231], v23 offset:36864
    v_cvt_pk_bf16_f32 v166, v140, v141
    v_exp_f32 v143, v143
    s_nop 0
    v_cvt_pk_bf16_f32 v167, v142, v143
    s_nop 1
    v_mfma_f32_16x16x32_bf16 v[248:251], v[12:15], v[160:163], v[248:251]
    v_mfma_f32_16x16x32_bf16 v[252:255], v[12:15], v[164:167], v[252:255]
    s_waitcnt lgkmcnt(14)
    v_mfma_f32_16x16x32_bf16 v[64:67], v[200:203], v[160:163], v[64:67]
    v_mfma_f32_16x16x32_bf16 v[68:71], v[200:203], v[164:167], v[68:71]
    s_waitcnt lgkmcnt(12)
    v_mfma_f32_16x16x32_bf16 v[72:75], v[204:207], v[160:163], v[72:75]
    v_mfma_f32_16x16x32_bf16 v[76:79], v[204:207], v[164:167], v[76:79]
    s_waitcnt lgkmcnt(10)
    v_mfma_f32_16x16x32_bf16 v[80:83], v[208:211], v[160:163], v[80:83]
    v_max3_f32 v26, v144, v145, v146
    v_mfma_f32_16x16x32_bf16 v[84:87], v[208:211], v[164:167], v[84:87]
    v_max3_f32 v26, v147, v152, v26
    s_waitcnt lgkmcnt(8)
    v_mfma_f32_16x16x32_bf16 v[88:91], v[212:215], v[160:163], v[88:91]
    v_max3_f32 v26, v153, v154, v26
    v_mfma_f32_16x16x32_bf16 v[92:95], v[212:215], v[164:167], v[92:95]
    v_max_f32 v26, v155, v26
    s_waitcnt lgkmcnt(6)
    v_mfma_f32_16x16x32_bf16 v[96:99], v[216:219], v[160:163], v[96:99]
    v_max3_f32 v27, v148, v149, v150
    v_mfma_f32_16x16x32_bf16 v[100:103], v[216:219], v[164:167], v[100:103]
    v_max3_f32 v27, v151, v156, v27
    s_waitcnt lgkmcnt(4)
    v_mfma_f32_16x16x32_bf16 v[104:107], v[220:223], v[160:163], v[104:107]
    v_max3_f32 v27, v157, v158, v27
    v_mfma_f32_16x16x32_bf16 v[108:111], v[220:223], v[164:167], v[108:111]
    v_max_f32 v27, v159, v27
    s_waitcnt lgkmcnt(2)
    v_mfma_f32_16x16x32_bf16 v[112:115], v[224:227], v[160:163], v[112:115]
    v_max_f32 v30, v26, v27
    v_mfma_f32_16x16x32_bf16 v[116:119], v[224:227], v[164:167], v[116:119]
    v_cmp_lt_f32 vcc, 0x41000000, v30
    s_waitcnt lgkmcnt(0)
    v_mfma_f32_16x16x32_bf16 v[120:123], v[228:231], v[160:163], v[120:123]
    v_mfma_f32_16x16x32_bf16 v[124:127], v[228:231], v[164:167], v[124:127]
    v_lshrrev_b32 v28, 4, v1
    v_bfe_u32 v29, v1, 2, 2
    v_lshl_add_u32 v30, v28, 2, v29
    v_bfe_u32 v31, v30, 1, 2
    v_and_b32 v28, 3, v1
    v_lshlrev_b32 v28, 3, v28
    v_lshl_add_u32 v28, v31, 5, v28
    v_lshl_add_u32 v28, v30, 7, v28
    v_add_u32 v28, s78, v28
    v_xor_b32 v2, 0, v28
    v_xor_b32 v3, 32, v28
    v_xor_b32 v4, 64, v28
    v_xor_b32 v5, 96, v28
    s_mov_b32 s64, 65536
    v_add_u32 v2, s64, v2
    v_add_u32 v3, s64, v3
    v_add_u32 v4, s64, v4
    v_add_u32 v5, s64, v5
    ds_read_b64_tr_b16 v[32:33], v2 offset:32768
    ds_read_b64_tr_b16 v[34:35], v2 offset:34816
    ds_read_b64_tr_b16 v[36:37], v3 offset:32768
    ds_read_b64_tr_b16 v[38:39], v3 offset:34816
    ds_read_b64_tr_b16 v[40:41], v4 offset:32768
    ds_read_b64_tr_b16 v[42:43], v4 offset:34816
    ds_read_b64_tr_b16 v[44:45], v5 offset:32768
    ds_read_b64_tr_b16 v[46:47], v5 offset:34816
    s_waitcnt lgkmcnt(4)
    s_mov_b32 s64, 65536
    v_add_u32 v2, s64, v2
    v_add_u32 v3, s64, v3
    v_add_u32 v4, s64, v4
    v_add_u32 v5, s64, v5
    ds_read_b64_tr_b16 v[48:49], v2 offset:0
    ds_read_b64_tr_b16 v[50:51], v2 offset:2048
    ds_read_b64_tr_b16 v[52:53], v3 offset:0
    ds_read_b64_tr_b16 v[54:55], v3 offset:2048
    ds_read_b64_tr_b16 v[56:57], v4 offset:0
    ds_read_b64_tr_b16 v[58:59], v4 offset:2048
    ds_read_b64_tr_b16 v[60:61], v5 offset:0
    ds_read_b64_tr_b16 v[62:63], v5 offset:2048
    s_add_u32 s61, s61, 1
    s_cbranch_vccnz L_resc_p31
L_back_p31:
    s_waitcnt vmcnt(0) lgkmcnt(0)
    s_barrier
    ds_read_b64_tr_b16 v[200:201], v16 offset:0
    ds_read_b64_tr_b16 v[202:203], v16 offset:4096
    ds_read_b64_tr_b16 v[204:205], v17 offset:0
    ds_read_b64_tr_b16 v[206:207], v17 offset:4096
    ds_read_b64_tr_b16 v[208:209], v18 offset:0
    ds_read_b64_tr_b16 v[210:211], v18 offset:4096
    ds_read_b64_tr_b16 v[212:213], v19 offset:0
    ds_read_b64_tr_b16 v[214:215], v19 offset:4096
    ds_read_b64_tr_b16 v[216:217], v20 offset:0
    ds_read_b64_tr_b16 v[218:219], v20 offset:4096
    ds_read_b64_tr_b16 v[220:221], v21 offset:0
    ds_read_b64_tr_b16 v[222:223], v21 offset:4096
    ds_read_b64_tr_b16 v[224:225], v22 offset:0
    ds_read_b64_tr_b16 v[226:227], v22 offset:4096
    ds_read_b64_tr_b16 v[228:229], v23 offset:0
    s_add_u32 s64, s78, 98304
    s_mov_b32 m0, s64
    s_lshl_b32 s65, s84, 15
    s_add_u32 s65, s65, 65536
    s_and_b32 s65, s65, 0x7ffff
    buffer_load_dwordx4 v236, s[40:43], s65 offen lds
    buffer_load_dwordx4 v237, s[40:43], s65 offen offset:1024 lds
    buffer_load_dwordx4 v238, s[40:43], s65 offen offset:2048 lds
    buffer_load_dwordx4 v239, s[40:43], s65 offen offset:3072 lds
    s_add_u32 s64, s78, 131072
    s_mov_b32 m0, s64
    s_lshl_b32 s65, s84, 15
    s_add_u32 s65, s65, 98304
    s_and_b32 s65, s65, 0x7ffff
    buffer_load_dwordx4 v236, s[40:43], s65 offen lds
    buffer_load_dwordx4 v237, s[40:43], s65 offen offset:1024 lds
    buffer_load_dwordx4 v238, s[40:43], s65 offen offset:2048 lds
    buffer_load_dwordx4 v239, s[40:43], s65 offen offset:3072 lds
    v_exp_f32 v144, v144
    v_exp_f32 v145, v145
    v_exp_f32 v146, v146
    v_cvt_pk_bf16_f32 v160, v144, v145
    v_exp_f32 v147, v147
    v_exp_f32 v152, v152
    v_cvt_pk_bf16_f32 v161, v146, v147
    v_exp_f32 v153, v153
    v_exp_f32 v154, v154
    s_waitcnt lgkmcnt(14)
    ds_read_b64_tr_b16 v[230:231], v23 offset:4096
    v_cvt_pk_bf16_f32 v162, v152, v153
    v_exp_f32 v155, v155
    v_exp_f32 v148, v148
    v_cvt_pk_bf16_f32 v163, v154, v155
    v_exp_f32 v149, v149
    v_exp_f32 v150, v150
    v_cvt_pk_bf16_f32 v164, v148, v149
    v_exp_f32 v151, v151
    v_exp_f32 v156, v156
    v_cvt_pk_bf16_f32 v165, v150, v151
    v_exp_f32 v157, v157
    v_exp_f32 v158, v158
    v_cvt_pk_bf16_f32 v166, v156, v157
    v_exp_f32 v159, v159
    s_nop 0
    v_cvt_pk_bf16_f32 v167, v158, v159
    s_nop 1
    v_mfma_f32_16x16x32_bf16 v[248:251], v[12:15], v[160:163], v[248:251]
    v_mfma_f32_16x16x32_bf16 v[252:255], v[12:15], v[164:167], v[252:255]
    s_waitcnt lgkmcnt(14)
    v_mfma_f32_16x16x32_bf16 v[64:67], v[200:203], v[160:163], v[64:67]
    v_mfma_f32_16x16x32_bf16 v[68:71], v[200:203], v[164:167], v[68:71]
    s_waitcnt lgkmcnt(12)
    v_mfma_f32_16x16x32_bf16 v[72:75], v[204:207], v[160:163], v[72:75]
    v_mfma_f32_16x16x32_bf16 v[76:79], v[204:207], v[164:167], v[76:79]
    s_waitcnt lgkmcnt(10)
    v_mfma_f32_16x16x32_bf16 v[80:83], v[208:211], v[160:163], v[80:83]
    v_mfma_f32_16x16x32_bf16 v[84:87], v[208:211], v[164:167], v[84:87]
    s_waitcnt lgkmcnt(8)
    v_mfma_f32_16x16x32_bf16 v[88:91], v[212:215], v[160:163], v[88:91]
    v_mfma_f32_16x16x32_bf16 v[92:95], v[212:215], v[164:167], v[92:95]
    s_waitcnt lgkmcnt(6)
    v_mfma_f32_16x16x32_bf16 v[96:99], v[216:219], v[160:163], v[96:99]
    v_mfma_f32_16x16x32_bf16 v[100:103], v[216:219], v[164:167], v[100:103]
    s_waitcnt lgkmcnt(4)
    v_mfma_f32_16x16x32_bf16 v[104:107], v[220:223], v[160:163], v[104:107]
    v_mfma_f32_16x16x32_bf16 v[108:111], v[220:223], v[164:167], v[108:111]
    s_waitcnt lgkmcnt(2)
    v_mfma_f32_16x16x32_bf16 v[112:115], v[224:227], v[160:163], v[112:115]
    v_mfma_f32_16x16x32_bf16 v[116:119], v[224:227], v[164:167], v[116:119]
    s_waitcnt lgkmcnt(0)
    v_mfma_f32_16x16x32_bf16 v[120:123], v[228:231], v[160:163], v[120:123]
    v_mfma_f32_16x16x32_bf16 v[124:127], v[228:231], v[164:167], v[124:127]
    s_add_u32 s61, s61, 1
    s_branch L_loopdone
L_resc_l0:
    s_getpc_b64 s[88:89]
    s_add_u32 s88, s88, L_back_l0-L_resc_l0-4
    s_addc_u32 s89, s89, -1
    s_branch L_resc1
L_resc_l1:
    s_getpc_b64 s[88:89]
    s_add_u32 s88, s88, L_back_l1-L_resc_l1-4
    s_addc_u32 s89, s89, -1
    s_branch L_resc0
L_resc_l2:
    s_getpc_b64 s[88:89]
    s_add_u32 s88, s88, L_back_l2-L_resc_l2-4
    s_addc_u32 s89, s89, -1
    s_branch L_resc1
L_resc_l3:
    s_getpc_b64 s[88:89]
    s_add_u32 s88, s88, L_back_l3-L_resc_l3-4
    s_addc_u32 s89, s89, -1
    s_branch L_resc0
L_resc_l4:
    s_getpc_b64 s[88:89]
    s_add_u32 s88, s88, L_back_l4-L_resc_l4-4
    s_addc_u32 s89, s89, -1
    s_branch L_resc1
L_resc_l5:
    s_getpc_b64 s[88:89]
    s_add_u32 s88, s88, L_back_l5-L_resc_l5-4
    s_addc_u32 s89, s89, -1
    s_branch L_resc0
L_resc_p25:
    s_getpc_b64 s[88:89]
    s_add_u32 s88, s88, L_back_p25-L_resc_p25-4
    s_addc_u32 s89, s89, -1
    s_branch L_resc1
L_resc_p26:
    s_getpc_b64 s[88:89]
    s_add_u32 s88, s88, L_back_p26-L_resc_p26-4
    s_addc_u32 s89, s89, -1
    s_branch L_resc0
L_resc_p27:
    s_getpc_b64 s[88:89]
    s_add_u32 s88, s88, L_back_p27-L_resc_p27-4
    s_addc_u32 s89, s89, -1
    s_branch L_resc1
L_resc_p28:
    s_getpc_b64 s[88:89]
    s_add_u32 s88, s88, L_back_p28-L_resc_p28-4
    s_addc_u32 s89, s89, -1
    s_branch L_resc0
L_resc_p29:
    s_getpc_b64 s[88:89]
    s_add_u32 s88, s88, L_back_p29-L_resc_p29-4
    s_addc_u32 s89, s89, -1
    s_branch L_resc1
L_resc_p30:
    s_getpc_b64 s[88:89]
    s_add_u32 s88, s88, L_back_p30-L_resc_p30-4
    s_addc_u32 s89, s89, -1
    s_branch L_resc0
L_resc_p31:
    s_getpc_b64 s[88:89]
    s_add_u32 s88, s88, L_back_p31-L_resc_p31-4
    s_addc_u32 s89, s89, -1
    s_branch L_resc1
L_resc0:
    v_mov_b32 v28, v26
    s_nop 1
    v_permlane32_swap_b32 v26, v28
    v_max_f32 v26, v26, v28
    v_mov_b32 v28, v26
    s_nop 1
    v_permlane16_swap_b32 v26, v28
    v_max_f32 v26, v26, v28
    v_max_f32 v26, 0, v26
    v_exp_f32 v30, -v26
    v_add_f32 v24, v24, v26
    v_sub_f32 v240, 0, v24
    v_sub_f32 v241, 0, v24
    v_sub_f32 v242, 0, v24
    v_sub_f32 v243, 0, v24
    v_sub_f32 v128, v128, v26
    v_sub_f32 v129, v129, v26
    v_sub_f32 v130, v130, v26
    v_sub_f32 v131, v131, v26
    v_sub_f32 v136, v136, v26
    v_sub_f32 v137, v137, v26
    v_sub_f32 v138, v138, v26
    v_sub_f32 v139, v139, v26
    v_mov_b32 v28, v27
    s_nop 1
    v_permlane32_swap_b32 v27, v28
    v_max_f32 v27, v27, v28
    v_mov_b32 v28, v27
    s_nop 1
    v_permlane16_swap_b32 v27, v28
    v_max_f32 v27, v27, v28
    v_max_f32 v27, 0, v27
    v_exp_f32 v31, -v27
    v_add_f32 v25, v25, v27
    v_sub_f32 v244, 0, v25
    v_sub_f32 v245, 0, v25
    v_sub_f32 v246, 0, v25
    v_sub_f32 v247, 0, v25
    v_sub_f32 v132, v132, v27
    v_sub_f32 v133, v133, v27
    v_sub_f32 v134, v134, v27
    v_sub_f32 v135, v135, v27
    v_sub_f32 v140, v140, v27
    v_sub_f32 v141, v141, v27
    v_sub_f32 v142, v142, v27
    v_sub_f32 v143, v143, v27
    v_mul_f32 v248, v248, v30
    v_mul_f32 v249, v249, v30
    v_mul_f32 v250, v250, v30
    v_mul_f32 v251, v251, v30
    v_mul_f32 v252, v252, v31
    v_mul_f32 v253, v253, v31
    v_mul_f32 v254, v254, v31
    v_mul_f32 v255, v255, v31
    v_mul_f32 v64, v64, v30
    v_mul_f32 v65, v65, v30
    v_mul_f32 v66, v66, v30
    v_mul_f32 v67, v67, v30
    v_mul_f32 v68, v68, v31
    v_mul_f32 v69, v69, v31
    v_mul_f32 v70, v70, v31
    v_mul_f32 v71, v71, v31
    v_mul_f32 v72, v72, v30
    v_mul_f32 v73, v73, v30
    v_mul_f32 v74, v74, v30
    v_mul_f32 v75, v75, v30
    v_mul_f32 v76, v76, v31
    v_mul_f32 v77, v77, v31
    v_mul_f32 v78, v78, v31
    v_mul_f32 v79, v79, v31
    v_mul_f32 v80, v80, v30
    v_mul_f32 v81, v81, v30
    v_mul_f32 v82, v82, v30
    v_mul_f32 v83, v83, v30
    v_mul_f32 v84, v84, v31
    v_mul_f32 v85, v85, v31
    v_mul_f32 v86, v86, v31
    v_mul_f32 v87, v87, v31
    v_mul_f32 v88, v88, v30
    v_mul_f32 v89, v89, v30
    v_mul_f32 v90, v90, v30
    v_mul_f32 v91, v91, v30
    v_mul_f32 v92, v92, v31
    v_mul_f32 v93, v93, v31
    v_mul_f32 v94, v94, v31
    v_mul_f32 v95, v95, v31
    v_mul_f32 v96, v96, v30
    v_mul_f32 v97, v97, v30
    v_mul_f32 v98, v98, v30
    v_mul_f32 v99, v99, v30
    v_mul_f32 v100, v100, v31
    v_mul_f32 v101, v101, v31
    v_mul_f32 v102, v102, v31
    v_mul_f32 v103, v103, v31
    v_mul_f32 v104, v104, v30
    v_mul_f32 v105, v105, v30
    v_mul_f32 v106, v106, v30
    v_mul_f32 v107, v107, v30
    v_mul_f32 v108, v108, v31
    v_mul_f32 v109, v109, v31
    v_mul_f32 v110, v110, v31
    v_mul_f32 v111, v111, v31
    v_mul_f32 v112, v112, v30
    v_mul_f32 v113, v113, v30
    v_mul_f32 v114, v114, v30
    v_mul_f32 v115, v115, v30
    v_mul_f32 v116, v116, v31
    v_mul_f32 v117, v117, v31
    v_mul_f32 v118, v118, v31
    v_mul_f32 v119, v119, v31
    v_mul_f32 v120, v120, v30
    v_mul_f32 v121, v121, v30
    v_mul_f32 v122, v122, v30
    v_mul_f32 v123, v123, v30
    v_mul_f32 v124, v124, v31
    v_mul_f32 v125, v125, v31
    v_mul_f32 v126, v126, v31
    v_mul_f32 v127, v127, v31
    s_setpc_b64 s[88:89]
L_resc1:
    v_mov_b32 v28, v26
    s_nop 1
    v_permlane32_swap_b32 v26, v28
    v_max_f32 v26, v26, v28
    v_mov_b32 v28, v26
    s_nop 1
    v_permlane16_swap_b32 v26, v28
    v_max_f32 v26, v26, v28
    v_max_f32 v26, 0, v26
    v_exp_f32 v30, -v26
    v_add_f32 v24, v24, v26
    v_sub_f32 v240, 0, v24
    v_sub_f32 v241, 0, v24
    v_sub_f32 v242, 0, v24
    v_sub_f32 v243, 0, v24
    v_sub_f32 v144, v144, v26
    v_sub_f32 v145, v145, v26
    v_sub_f32 v146, v146, v26
    v_sub_f32 v147, v147, v26
    v_sub_f32 v152, v152, v26
    v_sub_f32 v153, v153, v26
    v_sub_f32 v154, v154, v26
    v_sub_f32 v155, v155, v26
    v_mov_b32 v28, v27
    s_nop 1
    v_permlane32_swap_b32 v27, v28
    v_max_f32 v27, v27, v28
    v_mov_b32 v28, v27
    s_nop 1
    v_permlane16_swap_b32 v27, v28
    v_max_f32 v27, v27, v28
    v_max_f32 v27, 0, v27
    v_exp_f32 v31, -v27
    v_add_f32 v25, v25, v27
    v_sub_f32 v244, 0, v25
    v_sub_f32 v245, 0, v25
    v_sub_f32 v246, 0, v25
    v_sub_f32 v247, 0, v25
    v_sub_f32 v148, v148, v27
    v_sub_f32 v149, v149, v27
    v_sub_f32 v150, v150, v27
    v_sub_f32 v151, v151, v27
    v_sub_f32 v156, v156, v27
    v_sub_f32 v157, v157, v27
    v_sub_f32 v158, v158, v27
    v_sub_f32 v159, v159, v27
    v_mul_f32 v248, v248, v30
    v_mul_f32 v249, v249, v30
    v_mul_f32 v250, v250, v30
    v_mul_f32 v251, v251, v30
    v_mul_f32 v252, v252, v31
    v_mul_f32 v253, v253, v31
    v_mul_f32 v254, v254, v31
    v_mul_f32 v255, v255, v31
    v_mul_f32 v64, v64, v30
    v_mul_f32 v65, v65, v30
    v_mul_f32 v66, v66, v30
    v_mul_f32 v67, v67, v30
    v_mul_f32 v68, v68, v31
    v_mul_f32 v69, v69, v31
    v_mul_f32 v70, v70, v31
    v_mul_f32 v71, v71, v31
    v_mul_f32 v72, v72, v30
    v_mul_f32 v73, v73, v30
    v_mul_f32 v74, v74, v30
    v_mul_f32 v75, v75, v30
    v_mul_f32 v76, v76, v31
    v_mul_f32 v77, v77, v31
    v_mul_f32 v78, v78, v31
    v_mul_f32 v79, v79, v31
    v_mul_f32 v80, v80, v30
    v_mul_f32 v81, v81, v30
    v_mul_f32 v82, v82, v30
    v_mul_f32 v83, v83, v30
    v_mul_f32 v84, v84, v31
    v_mul_f32 v85, v85, v31
    v_mul_f32 v86, v86, v31
    v_mul_f32 v87, v87, v31
    v_mul_f32 v88, v88, v30
    v_mul_f32 v89, v89, v30
    v_mul_f32 v90, v90, v30
    v_mul_f32 v91, v91, v30
    v_mul_f32 v92, v92, v31
    v_mul_f32 v93, v93, v31
    v_mul_f32 v94, v94, v31
    v_mul_f32 v95, v95, v31
    v_mul_f32 v96, v96, v30
    v_mul_f32 v97, v97, v30
    v_mul_f32 v98, v98, v30
    v_mul_f32 v99, v99, v30
    v_mul_f32 v100, v100, v31
    v_mul_f32 v101, v101, v31
    v_mul_f32 v102, v102, v31
    v_mul_f32 v103, v103, v31
    v_mul_f32 v104, v104, v30
    v_mul_f32 v105, v105, v30
    v_mul_f32 v106, v106, v30
    v_mul_f32 v107, v107, v30
    v_mul_f32 v108, v108, v31
    v_mul_f32 v109, v109, v31
    v_mul_f32 v110, v110, v31
    v_mul_f32 v111, v111, v31
    v_mul_f32 v112, v112, v30
    v_mul_f32 v113, v113, v30
    v_mul_f32 v114, v114, v30
    v_mul_f32 v115, v115, v30
    v_mul_f32 v116, v116, v31
    v_mul_f32 v117, v117, v31
    v_mul_f32 v118, v118, v31
    v_mul_f32 v119, v119, v31
    v_mul_f32 v120, v120, v30
    v_mul_f32 v121, v121, v30
    v_mul_f32 v122, v122, v30
    v_mul_f32 v123, v123, v30
    v_mul_f32 v124, v124, v31
    v_mul_f32 v125, v125, v31
    v_mul_f32 v126, v126, v31
    v_mul_f32 v127, v127, v31
    s_setpc_b64 s[88:89]
L_loopdone:
    v_lshlrev_b32 v128, 4, v1
    s_lshl_b32 s64, s53, 13
    v_add_u32 v129, s64, v128
    s_cmp_eq_u32 s54, 0
    s_cselect_b32 s64, 0, 65536
    s_cselect_b32 s65, 65536, 0
    v_add_u32 v130, s65, v129
    v_add_u32 v129, s64, v129
    s_lshl_b32 s64, s52, 10
    s_add_u32 s64, s64, 32768
    v_add_u32 v131, s64, v128
    ds_write_b128 v129, v[96:99] offset:0
    ds_write_b128 v129, v[100:103] offset:1024
    ds_write_b128 v129, v[104:107] offset:2048
    ds_write_b128 v129, v[108:111] offset:3072
    ds_write_b128 v129, v[112:115] offset:4096
    ds_write_b128 v129, v[116:119] offset:5120
    ds_write_b128 v129, v[120:123] offset:6144
    ds_write_b128 v129, v[124:127] offset:7168
    v_mov_b32 v140, v24
    v_mov_b32 v142, v248
    v_mov_b32 v141, v25
    v_mov_b32 v143, v252
    ds_write_b128 v131, v[140:143]
    v_xor_b32 v131, 4096, v131
    s_waitcnt lgkmcnt(0)
    s_barrier
    ds_read_b128 v[132:135], v131
    ds_read_b128 v[168:171], v130 offset:0
    ds_read_b128 v[172:175], v130 offset:1024
    ds_read_b128 v[176:179], v130 offset:2048
    ds_read_b128 v[180:183], v130 offset:3072
    ds_read_b128 v[184:187], v130 offset:4096
    ds_read_b128 v[188:191], v130 offset:5120
    ds_read_b128 v[192:195], v130 offset:6144
    ds_read_b128 v[196:199], v130 offset:7168
    s_lshl_b32 s64, s53, 18
    s_lshl_b32 s65, s54, 12
    s_add_u32 s66, s64, s65
    s_waitcnt lgkmcnt(8)
    v_max_f32 v136, v24, v132
    v_sub_f32 v28, v24, v136
    v_sub_f32 v30, v132, v136
    v_exp_f32 v28, v28
    v_exp_f32 v30, v30
    v_max_f32 v137, v25, v133
    v_sub_f32 v29, v25, v137
    v_sub_f32 v31, v133, v137
    v_exp_f32 v29, v29
    v_exp_f32 v31, v31
    v_mul_f32 v136, v142, v28
    v_fma_f32 v136, v134, v30, v136
    v_mul_f32 v137, v143, v29
    v_fma_f32 v137, v135, v31, v137
    v_rcp_f32 v136, v136
    v_rcp_f32 v137, v137
    s_nop 0
    v_mul_f32 v28, v28, v136
    v_mul_f32 v30, v30, v136
    v_mul_f32 v29, v29, v137
    v_mul_f32 v31, v31, v137
    v_mul_f32 v64, v64, v28
    v_mul_f32 v65, v65, v28
    v_mul_f32 v66, v66, v28
    v_mul_f32 v67, v67, v28
    v_mul_f32 v68, v68, v29
    v_mul_f32 v69, v69, v29
    v_mul_f32 v70, v70, v29
    v_mul_f32 v71, v71, v29
    v_mul_f32 v72, v72, v28
    v_mul_f32 v73, v73, v28
    v_mul_f32 v74, v74, v28
    v_mul_f32 v75, v75, v28
    v_mul_f32 v76, v76, v29
    v_mul_f32 v77, v77, v29
    v_mul_f32 v78, v78, v29
    v_mul_f32 v79, v79, v29
    v_mul_f32 v80, v80, v28
    v_mul_f32 v81, v81, v28
    v_mul_f32 v82, v82, v28
    v_mul_f32 v83, v83, v28
    v_mul_f32 v84, v84, v29
    v_mul_f32 v85, v85, v29
    v_mul_f32 v86, v86, v29
    v_mul_f32 v87, v87, v29
    v_mul_f32 v88, v88, v28
    v_mul_f32 v89, v89, v28
    v_mul_f32 v90, v90, v28
    v_mul_f32 v91, v91, v28
    v_mul_f32 v92, v92, v29
    v_mul_f32 v93, v93, v29
    v_mul_f32 v94, v94, v29
    v_mul_f32 v95, v95, v29
    s_waitcnt lgkmcnt(4)
    v_fma_f32 v64, v168, v30, v64
    v_fma_f32 v65, v169, v30, v65
    v_fma_f32 v66, v170, v30, v66
    v_fma_f32 v67, v171, v30, v67
    v_fma_f32 v68, v172, v31, v68
    v_fma_f32 v69, v173, v31, v69
    v_fma_f32 v70, v174, v31, v70
    v_fma_f32 v71, v175, v31, v71
    v_fma_f32 v72, v176, v30, v72
    v_fma_f32 v73, v177, v30, v73
    v_fma_f32 v74, v178, v30, v74
    v_fma_f32 v75, v179, v30, v75
    v_fma_f32 v76, v180, v31, v76
    v_fma_f32 v77, v181, v31, v77
    v_fma_f32 v78, v182, v31, v78
    v_fma_f32 v79, v183, v31, v79
    v_cvt_pk_bf16_f32 v200, v64, v65
    v_cvt_pk_bf16_f32 v201, v66, v67
    v_cvt_pk_bf16_f32 v202, v72, v73
    v_cvt_pk_bf16_f32 v203, v74, v75
    buffer_store_dwordx4 v[200:203], v128, s[36:39], s66 offen offset:0 sc1
    v_cvt_pk_bf16_f32 v204, v68, v69
    v_cvt_pk_bf16_f32 v205, v70, v71
    v_cvt_pk_bf16_f32 v206, v76, v77
    v_cvt_pk_bf16_f32 v207, v78, v79
    buffer_store_dwordx4 v[204:207], v128, s[36:39], s66 offen offset:1024 sc1
    s_waitcnt lgkmcnt(0)
    v_fma_f32 v80, v184, v30, v80
    v_fma_f32 v81, v185, v30, v81
    v_fma_f32 v82, v186, v30, v82
    v_fma_f32 v83, v187, v30, v83
    v_fma_f32 v84, v188, v31, v84
    v_fma_f32 v85, v189, v31, v85
    v_fma_f32 v86, v190, v31, v86
    v_fma_f32 v87, v191, v31, v87
    v_fma_f32 v88, v192, v30, v88
    v_fma_f32 v89, v193, v30, v89
    v_fma_f32 v90, v194, v30, v90
    v_fma_f32 v91, v195, v30, v91
    v_fma_f32 v92, v196, v31, v92
    v_fma_f32 v93, v197, v31, v93
    v_fma_f32 v94, v198, v31, v94
    v_fma_f32 v95, v199, v31, v95
    v_cvt_pk_bf16_f32 v208, v80, v81
    v_cvt_pk_bf16_f32 v209, v82, v83
    v_cvt_pk_bf16_f32 v210, v88, v89
    v_cvt_pk_bf16_f32 v211, v90, v91
    buffer_store_dwordx4 v[208:211], v128, s[36:39], s66 offen offset:2048 sc1
    v_cvt_pk_bf16_f32 v212, v84, v85
    v_cvt_pk_bf16_f32 v213, v86, v87
    v_cvt_pk_bf16_f32 v214, v92, v93
    v_cvt_pk_bf16_f32 v215, v94, v95
    buffer_store_dwordx4 v[212:215], v128, s[36:39], s66 offen offset:3072 sc1
    v_mov_b32 v24, v236
    v_mov_b32 v25, v237
    v_mov_b32 v26, v238
    v_mov_b32 v27, v239
    v_lshlrev_b32 v6, 4, v1
    s_lshl_b32 s64, s69, 5
    s_lshl_b32 s65, s52, 2
    s_add_u32 s64, s64, s65
    v_mov_b32 v31, s64
    s_waitcnt vmcnt(8)
    s_mov_b32 s64, -65536
    v_add_u32 v2, s64, v2
    v_add_u32 v3, s64, v3
    v_add_u32 v4, s64, v4
    v_add_u32 v5, s64, v5
    ds_read_b64_tr_b16 v[64:65], v2 offset:32768
    ds_read_b64_tr_b16 v[66:67], v2 offset:34816
    ds_read_b64_tr_b16 v[68:69], v3 offset:32768
    ds_read_b64_tr_b16 v[70:71], v3 offset:34816
    ds_read_b64_tr_b16 v[72:73], v4 offset:32768
    ds_read_b64_tr_b16 v[74:75], v4 offset:34816
    ds_read_b64_tr_b16 v[76:77], v5 offset:32768
    ds_read_b64_tr_b16 v[78:79], v5 offset:34816
    s_waitcnt lgkmcnt(0)
    s_add_u32 s64, s78, 98304
    s_mov_b32 m0, s64
    s_lshl_b32 s65, s84, 15
    s_add_u32 s65, s65, 131072
    s_and_b32 s65, s65, 0x7ffff
    buffer_load_dwordx4 v24, s[40:43], s65 offen lds
    buffer_load_dwordx4 v25, s[40:43], s65 offen offset:1024 lds
    buffer_load_dwordx4 v26, s[40:43], s65 offen offset:2048 lds
    buffer_load_dwordx4 v27, s[40:43], s65 offen offset:3072 lds
    s_waitcnt vmcnt(8)
    s_mov_b32 s64, 65536
    v_add_u32 v2, s64, v2
    v_add_u32 v3, s64, v3
    v_add_u32 v4, s64, v4
    v_add_u32 v5, s64, v5
    ds_read_b64_tr_b16 v[80:81], v2 offset:0
    ds_read_b64_tr_b16 v[82:83], v2 offset:2048
    ds_read_b64_tr_b16 v[84:85], v3 offset:0
    ds_read_b64_tr_b16 v[86:87], v3 offset:2048
    ds_read_b64_tr_b16 v[88:89], v4 offset:0
    ds_read_b64_tr_b16 v[90:91], v4 offset:2048
    ds_read_b64_tr_b16 v[92:93], v5 offset:0
    ds_read_b64_tr_b16 v[94:95], v5 offset:2048
    s_waitcnt lgkmcnt(0)
    s_add_u32 s64, s78, 131072
    s_mov_b32 m0, s64
    s_lshl_b32 s65, s84, 15
    s_add_u32 s65, s65, 163840
    s_and_b32 s65, s65, 0x7ffff
    buffer_load_dwordx4 v24, s[40:43], s65 offen lds
    buffer_load_dwordx4 v25, s[40:43], s65 offen offset:1024 lds
    buffer_load_dwordx4 v26, s[40:43], s65 offen offset:2048 lds
    buffer_load_dwordx4 v27, s[40:43], s65 offen offset:3072 lds
    s_waitcnt vmcnt(8)
    s_barrier
    s_cmp_lg_u32 s52, 0
    s_cbranch_scc1 L_noflag
    s_lshl_b32 s64, s55, 5
    s_add_u32 s64, s64, s56
    v_mov_b32 v28, 1
    v_mov_b32 v29, s64
    s_mov_b64 exec, 1
    buffer_store_byte v28, v29, s[48:51], 0 offen sc1
    s_mov_b64 exec, -1
L_noflag:
    s_add_u32 s64, s78, 0
    s_mov_b32 m0, s64
    s_lshl_b32 s65, s84, 15
    s_add_u32 s65, s65, 196608
    s_and_b32 s65, s65, 0x7ffff
    buffer_load_dwordx4 v24, s[40:43], s65 offen lds
    buffer_load_dwordx4 v25, s[40:43], s65 offen offset:1024 lds
    buffer_load_dwordx4 v26, s[40:43], s65 offen offset:2048 lds
    buffer_load_dwordx4 v27, s[40:43], s65 offen offset:3072 lds
    s_add_u32 s64, s78, 65536
    s_mov_b32 m0, s64
    s_lshl_b32 s65, s84, 15
    s_add_u32 s65, s65, 229376
    s_and_b32 s65, s65, 0x7ffff
    buffer_load_dwordx4 v24, s[40:43], s65 offen lds
    buffer_load_dwordx4 v25, s[40:43], s65 offen offset:1024 lds
    buffer_load_dwordx4 v26, s[40:43], s65 offen offset:2048 lds
    buffer_load_dwordx4 v27, s[40:43], s65 offen offset:3072 lds
    s_add_u32 s64, s78, 32768
    s_mov_b32 m0, s64
    s_lshl_b32 s65, s84, 15
    s_add_u32 s65, s65, 262144
    s_and_b32 s65, s65, 0x7ffff
    buffer_load_dwordx4 v24, s[40:43], s65 offen lds
    buffer_load_dwordx4 v25, s[40:43], s65 offen offset:1024 lds
    buffer_load_dwordx4 v26, s[40:43], s65 offen offset:2048 lds
    buffer_load_dwordx4 v27, s[40:43], s65 offen offset:3072 lds
    s_waitcnt vmcnt(16)
    s_mov_b32 s64, -65536
    v_add_u32 v2, s64, v2
    v_add_u32 v3, s64, v3
    v_add_u32 v4, s64, v4
    v_add_u32 v5, s64, v5
    ds_read_b64_tr_b16 v[96:97], v2 offset:32768
    ds_read_b64_tr_b16 v[98:99], v2 offset:34816
    ds_read_b64_tr_b16 v[100:101], v3 offset:32768
    ds_read_b64_tr_b16 v[102:103], v3 offset:34816
    ds_read_b64_tr_b16 v[104:105], v4 offset:32768
    ds_read_b64_tr_b16 v[106:107], v4 offset:34816
    ds_read_b64_tr_b16 v[108:109], v5 offset:32768
    ds_read_b64_tr_b16 v[110:111], v5 offset:34816
    s_waitcnt lgkmcnt(0)
    s_add_u32 s64, s78, 98304
    s_mov_b32 m0, s64
    s_lshl_b32 s65, s84, 15
    s_add_u32 s65, s65, 294912
    s_and_b32 s65, s65, 0x7ffff
    buffer_load_dwordx4 v24, s[40:43], s65 offen lds
    buffer_load_dwordx4 v25, s[40:43], s65 offen offset:1024 lds
    buffer_load_dwordx4 v26, s[40:43], s65 offen offset:2048 lds
    buffer_load_dwordx4 v27, s[40:43], s65 offen offset:3072 lds
    s_waitcnt vmcnt(16)
    s_mov_b32 s64, 65536
    v_add_u32 v2, s64, v2
    v_add_u32 v3, s64, v3
    v_add_u32 v4, s64, v4
    v_add_u32 v5, s64, v5
    ds_read_b64_tr_b16 v[112:113], v2 offset:0
    ds_read_b64_tr_b16 v[114:115], v2 offset:2048
    ds_read_b64_tr_b16 v[116:117], v3 offset:0
    ds_read_b64_tr_b16 v[118:119], v3 offset:2048
    ds_read_b64_tr_b16 v[120:121], v4 offset:0
    ds_read_b64_tr_b16 v[122:123], v4 offset:2048
    ds_read_b64_tr_b16 v[124:125], v5 offset:0
    ds_read_b64_tr_b16 v[126:127], v5 offset:2048
    s_waitcnt lgkmcnt(0)
    s_add_u32 s64, s78, 131072
    s_mov_b32 m0, s64
    s_lshl_b32 s65, s84, 15
    s_add_u32 s65, s65, 327680
    s_and_b32 s65, s65, 0x7ffff
    buffer_load_dwordx4 v24, s[40:43], s65 offen lds
    buffer_load_dwordx4 v25, s[40:43], s65 offen offset:1024 lds
    buffer_load_dwordx4 v26, s[40:43], s65 offen offset:2048 lds
    buffer_load_dwordx4 v27, s[40:43], s65 offen offset:3072 lds
    s_waitcnt vmcnt(16)
    s_mov_b32 s64, -131072
    v_add_u32 v2, s64, v2
    v_add_u32 v3, s64, v3
    v_add_u32 v4, s64, v4
    v_add_u32 v5, s64, v5
    ds_read_b64_tr_b16 v[128:129], v2 offset:0
    ds_read_b64_tr_b16 v[130:131], v2 offset:2048
    ds_read_b64_tr_b16 v[132:133], v3 offset:0
    ds_read_b64_tr_b16 v[134:135], v3 offset:2048
    ds_read_b64_tr_b16 v[136:137], v4 offset:0
    ds_read_b64_tr_b16 v[138:139], v4 offset:2048
    ds_read_b64_tr_b16 v[140:141], v5 offset:0
    ds_read_b64_tr_b16 v[142:143], v5 offset:2048
    s_waitcnt lgkmcnt(0)
    s_add_u32 s64, s78, 0
    s_mov_b32 m0, s64
    s_lshl_b32 s65, s84, 15
    s_add_u32 s65, s65, 360448
    s_and_b32 s65, s65, 0x7ffff
    buffer_load_dwordx4 v24, s[40:43], s65 offen lds
    buffer_load_dwordx4 v25, s[40:43], s65 offen offset:1024 lds
    buffer_load_dwordx4 v26, s[40:43], s65 offen offset:2048 lds
    buffer_load_dwordx4 v27, s[40:43], s65 offen offset:3072 lds
    s_waitcnt vmcnt(16)
    s_mov_b32 s64, 65536
    v_add_u32 v2, s64, v2
    v_add_u32 v3, s64, v3
    v_add_u32 v4, s64, v4
    v_add_u32 v5, s64, v5
    ds_read_b64_tr_b16 v[144:145], v2 offset:0
    ds_read_b64_tr_b16 v[146:147], v2 offset:2048
    ds_read_b64_tr_b16 v[148:149], v3 offset:0
    ds_read_b64_tr_b16 v[150:151], v3 offset:2048
    ds_read_b64_tr_b16 v[152:153], v4 offset:0
    ds_read_b64_tr_b16 v[154:155], v4 offset:2048
    ds_read_b64_tr_b16 v[156:157], v5 offset:0
    ds_read_b64_tr_b16 v[158:159], v5 offset:2048
    s_waitcnt lgkmcnt(0)
    s_add_u32 s64, s78, 65536
    s_mov_b32 m0, s64
    s_lshl_b32 s65, s84, 15
    s_add_u32 s65, s65, 393216
    s_and_b32 s65, s65, 0x7ffff
    buffer_load_dwordx4 v24, s[40:43], s65 offen lds
    buffer_load_dwordx4 v25, s[40:43], s65 offen offset:1024 lds
    buffer_load_dwordx4 v26, s[40:43], s65 offen offset:2048 lds
    buffer_load_dwordx4 v27, s[40:43], s65 offen offset:3072 lds
    s_waitcnt vmcnt(16)
    s_mov_b32 s64, -65536
    v_add_u32 v2, s64, v2
    v_add_u32 v3, s64, v3
    v_add_u32 v4, s64, v4
    v_add_u32 v5, s64, v5
    ds_read_b64_tr_b16 v[160:161], v2 offset:32768
    ds_read_b64_tr_b16 v[162:163], v2 offset:34816
    ds_read_b64_tr_b16 v[164:165], v3 offset:32768
    ds_read_b64_tr_b16 v[166:167], v3 offset:34816
    ds_read_b64_tr_b16 v[168:169], v4 offset:32768
    ds_read_b64_tr_b16 v[170:171], v4 offset:34816
    ds_read_b64_tr_b16 v[172:173], v5 offset:32768
    ds_read_b64_tr_b16 v[174:175], v5 offset:34816
    s_waitcnt lgkmcnt(0)
    s_add_u32 s64, s78, 32768
    s_mov_b32 m0, s64
    s_lshl_b32 s65, s84, 15
    s_add_u32 s65, s65, 425984
    s_and_b32 s65, s65, 0x7ffff
    buffer_load_dwordx4 v24, s[40:43], s65 offen lds
    buffer_load_dwordx4 v25, s[40:43], s65 offen offset:1024 lds
    buffer_load_dwordx4 v26, s[40:43], s65 offen offset:2048 lds
    buffer_load_dwordx4 v27, s[40:43], s65 offen offset:3072 lds
    s_waitcnt vmcnt(16)
    s_mov_b32 s64, 65536
    v_add_u32 v2, s64, v2
    v_add_u32 v3, s64, v3
    v_add_u32 v4, s64, v4
    v_add_u32 v5, s64, v5
    ds_read_b64_tr_b16 v[176:177], v2 offset:32768
    ds_read_b64_tr_b16 v[178:179], v2 offset:34816
    ds_read_b64_tr_b16 v[180:181], v3 offset:32768
    ds_read_b64_tr_b16 v[182:183], v3 offset:34816
    ds_read_b64_tr_b16 v[184:185], v4 offset:32768
    ds_read_b64_tr_b16 v[186:187], v4 offset:34816
    ds_read_b64_tr_b16 v[188:189], v5 offset:32768
    ds_read_b64_tr_b16 v[190:191], v5 offset:34816
    s_waitcnt lgkmcnt(0)
    s_add_u32 s64, s78, 98304
    s_mov_b32 m0, s64
    s_lshl_b32 s65, s84, 15
    s_add_u32 s65, s65, 458752
    s_and_b32 s65, s65, 0x7ffff
    buffer_load_dwordx4 v24, s[40:43], s65 offen lds
    buffer_load_dwordx4 v25, s[40:43], s65 offen offset:1024 lds
    buffer_load_dwordx4 v26, s[40:43], s65 offen offset:2048 lds
    buffer_load_dwordx4 v27, s[40:43], s65 offen offset:3072 lds
    s_waitcnt vmcnt(16)
    s_mov_b32 s64, 65536
    v_add_u32 v2, s64, v2
    v_add_u32 v3, s64, v3
    v_add_u32 v4, s64, v4
    v_add_u32 v5, s64, v5
    ds_read_b64_tr_b16 v[8:9], v2 offset:0
    ds_read_b64_tr_b16 v[10:11], v2 offset:2048
    ds_read_b64_tr_b16 v[12:13], v3 offset:0
    ds_read_b64_tr_b16 v[14:15], v3 offset:2048
    ds_read_b64_tr_b16 v[16:17], v4 offset:0
    ds_read_b64_tr_b16 v[18:19], v4 offset:2048
    ds_read_b64_tr_b16 v[20:21], v5 offset:0
    ds_read_b64_tr_b16 v[22:23], v5 offset:2048
    s_waitcnt lgkmcnt(0)
    s_add_u32 s64, s78, 131072
    s_mov_b32 m0, s64
    s_lshl_b32 s65, s84, 15
    s_add_u32 s65, s65, 491520
    s_and_b32 s65, s65, 0x7ffff
    buffer_load_dwordx4 v24, s[40:43], s65 offen lds
    buffer_load_dwordx4 v25, s[40:43], s65 offen offset:1024 lds
    buffer_load_dwordx4 v26, s[40:43], s65 offen offset:2048 lds
    buffer_load_dwordx4 v27, s[40:43], s65 offen offset:3072 lds
    buffer_load_dword v28, v31, s[48:51], 0 offen sc1
    s_waitcnt vmcnt(0)
    v_readfirstlane_b32 s79, v28
    s_nop 1
    s_add_u32 s65, s84, 0
    s_and_b32 s65, s65, 15
    s_lshr_b32 s66, s65, 2
    s_lshl_b32 s66, s66, 3
    s_lshl_b32 s65, s65, 11
L_p0:
    s_lshr_b32 s64, s79, s66
    s_and_b32 s64, s64, 0xff
    s_cbranch_scc1 L_go0
    s_sleep 4
    buffer_load_dword v28, v31, s[48:51], 0 offen sc1
    s_waitcnt vmcnt(0)
    v_readfirstlane_b32 s79, v28
    s_nop 1
    s_branch L_p0
L_go0:
    buffer_load_dwordx4 v[192:195], v6, s[80:83], s65 offen offset:0 sc1
    buffer_load_dwordx4 v[196:199], v6, s[80:83], s65 offen offset:1024 sc1
    buffer_load_dwordx4 v[200:203], v6, s[80:83], s65 offen offset:2048 sc1
    buffer_load_dwordx4 v[204:207], v6, s[80:83], s65 offen offset:3072 sc1
    s_add_u32 s65, s84, 2
    s_and_b32 s65, s65, 15
    s_lshr_b32 s66, s65, 2
    s_lshl_b32 s66, s66, 3
    s_lshl_b32 s65, s65, 11
L_p2:
    s_lshr_b32 s64, s79, s66
    s_and_b32 s64, s64, 0xff
    s_cbranch_scc1 L_go2
    s_sleep 4
    buffer_load_dword v28, v31, s[48:51], 0 offen sc1
    s_waitcnt vmcnt(0)
    v_readfirstlane_b32 s79, v28
    s_nop 1
    s_branch L_p2
L_go2:
    buffer_load_dwordx4 v[208:211], v6, s[80:83], s65 offen offset:0 sc1
    buffer_load_dwordx4 v[212:215], v6, s[80:83], s65 offen offset:1024 sc1
    buffer_load_dwordx4 v[216:219], v6, s[80:83], s65 offen offset:2048 sc1
    buffer_load_dwordx4 v[220:223], v6, s[80:83], s65 offen offset:3072 sc1
    s_waitcnt vmcnt(6)
    v_mfma_f32_16x16x32_bf16 v[224:227], v[32:35], v[192:195], 0
    v_mfma_f32_16x16x32_bf16 v[228:231], v[32:35], v[196:199], 0
    v_mfma_f32_16x16x32_bf16 v[232:235], v[36:39], v[192:195], 0
    v_mfma_f32_16x16x32_bf16 v[236:239], v[36:39], v[196:199], 0
    v_mfma_f32_16x16x32_bf16 v[240:243], v[40:43], v[192:195], 0
    v_mfma_f32_16x16x32_bf16 v[244:247], v[40:43], v[196:199], 0
    v_mfma_f32_16x16x32_bf16 v[248:251], v[44:47], v[192:195], 0
    v_mfma_f32_16x16x32_bf16 v[252:255], v[44:47], v[196:199], 0
    s_add_u32 s65, s84, 4
    s_and_b32 s65, s65, 15
    s_lshr_b32 s66, s65, 2
    s_lshl_b32 s66, s66, 3
    s_lshl_b32 s65, s65, 11
L_p4:
    s_lshr_b32 s64, s79, s66
    s_and_b32 s64, s64, 0xff
    s_cbranch_scc1 L_go4
    s_sleep 4
    buffer_load_dword v28, v31, s[48:51], 0 offen sc1
    s_waitcnt vmcnt(0)
    v_readfirstlane_b32 s79, v28
    s_nop 1
    s_branch L_p4
L_go4:
    buffer_load_dwordx4 v[192:195], v6, s[80:83], s65 offen offset:0 sc1
    buffer_load_dwordx4 v[196:199], v6, s[80:83], s65 offen offset:1024 sc1
    s_mov_b32 s64, -131072
    v_add_u32 v2, s64, v2
    v_add_u32 v3, s64, v3
    v_add_u32 v4, s64, v4
    v_add_u32 v5, s64, v5
    ds_read_b64_tr_b16 v[32:33], v2 offset:0
    ds_read_b64_tr_b16 v[34:35], v2 offset:2048
    ds_read_b64_tr_b16 v[36:37], v3 offset:0
    ds_read_b64_tr_b16 v[38:39], v3 offset:2048
    ds_read_b64_tr_b16 v[40:41], v4 offset:0
    ds_read_b64_tr_b16 v[42:43], v4 offset:2048
    ds_read_b64_tr_b16 v[44:45], v5 offset:0
    ds_read_b64_tr_b16 v[46:47], v5 offset:2048
    s_waitcnt vmcnt(6)
    v_mfma_f32_16x16x32_bf16 v[224:227], v[48:51], v[200:203], v[224:227]
    v_mfma_f32_16x16x32_bf16 v[228:231], v[48:51], v[204:207], v[228:231]
    v_mfma_f32_16x16x32_bf16 v[232:235], v[52:55], v[200:203], v[232:235]
    v_mfma_f32_16x16x32_bf16 v[236:239], v[52:55], v[204:207], v[236:239]
    v_mfma_f32_16x16x32_bf16 v[240:243], v[56:59], v[200:203], v[240:243]
    v_mfma_f32_16x16x32_bf16 v[244:247], v[56:59], v[204:207], v[244:247]
    v_mfma_f32_16x16x32_bf16 v[248:251], v[60:63], v[200:203], v[248:251]
    v_mfma_f32_16x16x32_bf16 v[252:255], v[60:63], v[204:207], v[252:255]
    buffer_load_dwordx4 v[200:203], v6, s[80:83], s65 offen offset:2048 sc1
    buffer_load_dwordx4 v[204:207], v6, s[80:83], s65 offen offset:3072 sc1
    s_waitcnt lgkmcnt(4)
    s_mov_b32 s64, 65536
    v_add_u32 v2, s64, v2
    v_add_u32 v3, s64, v3
    v_add_u32 v4, s64, v4
    v_add_u32 v5, s64, v5
    ds_read_b64_tr_b16 v[48:49], v2 offset:0
    ds_read_b64_tr_b16 v[50:51], v2 offset:2048
    ds_read_b64_tr_b16 v[52:53], v3 offset:0
    ds_read_b64_tr_b16 v[54:55], v3 offset:2048
    ds_read_b64_tr_b16 v[56:57], v4 offset:0
    ds_read_b64_tr_b16 v[58:59], v4 offset:2048
    ds_read_b64_tr_b16 v[60:61], v5 offset:0
    ds_read_b64_tr_b16 v[62:63], v5 offset:2048
    s_waitcnt vmcnt(6)
    v_mfma_f32_16x16x32_bf16 v[224:227], v[64:67], v[208:211], v[224:227]
    v_mfma_f32_16x16x32_bf16 v[228:231], v[64:67], v[212:215], v[228:231]
    v_mfma_f32_16x16x32_bf16 v[232:235], v[68:71], v[208:211], v[232:235]
    v_mfma_f32_16x16x32_bf16 v[236:239], v[68:71], v[212:215], v[236:239]
    v_mfma_f32_16x16x32_bf16 v[240:243], v[72:75], v[208:211], v[240:243]
    v_mfma_f32_16x16x32_bf16 v[244:247], v[72:75], v[212:215], v[244:247]
    v_mfma_f32_16x16x32_bf16 v[248:251], v[76:79], v[208:211], v[248:251]
    v_mfma_f32_16x16x32_bf16 v[252:255], v[76:79], v[212:215], v[252:255]
    s_add_u32 s65, s84, 6
    s_and_b32 s65, s65, 15
    s_lshr_b32 s66, s65, 2
    s_lshl_b32 s66, s66, 3
    s_lshl_b32 s65, s65, 11
L_p6:
    s_lshr_b32 s64, s79, s66
    s_and_b32 s64, s64, 0xff
    s_cbranch_scc1 L_go6
    s_sleep 4
    buffer_load_dword v28, v31, s[48:51], 0 offen sc1
    s_waitcnt vmcnt(0)
    v_readfirstlane_b32 s79, v28
    s_nop 1
    s_branch L_p6
L_go6:
    buffer_load_dwordx4 v[208:211], v6, s[80:83], s65 offen offset:0 sc1
    buffer_load_dwordx4 v[212:215], v6, s[80:83], s65 offen offset:1024 sc1
    s_waitcnt lgkmcnt(4)
    s_mov_b32 s64, -65536
    v_add_u32 v2, s64, v2
    v_add_u32 v3, s64, v3
    v_add_u32 v4, s64, v4
    v_add_u32 v5, s64, v5
    ds_read_b64_tr_b16 v[64:65], v2 offset:32768
    ds_read_b64_tr_b16 v[66:67], v2 offset:34816
    ds_read_b64_tr_b16 v[68:69], v3 offset:32768
    ds_read_b64_tr_b16 v[70:71], v3 offset:34816
    ds_read_b64_tr_b16 v[72:73], v4 offset:32768
    ds_read_b64_tr_b16 v[74:75], v4 offset:34816
    ds_read_b64_tr_b16 v[76:77], v5 offset:32768
    ds_read_b64_tr_b16 v[78:79], v5 offset:34816
    s_waitcnt vmcnt(6)
    v_mfma_f32_16x16x32_bf16 v[224:227], v[80:83], v[216:219], v[224:227]
    v_mfma_f32_16x16x32_bf16 v[228:231], v[80:83], v[220:223], v[228:231]
    v_mfma_f32_16x16x32_bf16 v[232:235], v[84:87], v[216:219], v[232:235]
    v_mfma_f32_16x16x32_bf16 v[236:239], v[84:87], v[220:223], v[236:239]
    v_mfma_f32_16x16x32_bf16 v[240:243], v[88:91], v[216:219], v[240:243]
    v_mfma_f32_16x16x32_bf16 v[244:247], v[88:91], v[220:223], v[244:247]
    v_mfma_f32_16x16x32_bf16 v[248:251], v[92:95], v[216:219], v[248:251]
    v_mfma_f32_16x16x32_bf16 v[252:255], v[92:95], v[220:223], v[252:255]
    buffer_load_dwordx4 v[216:219], v6, s[80:83], s65 offen offset:2048 sc1
    buffer_load_dwordx4 v[220:223], v6, s[80:83], s65 offen offset:3072 sc1
    s_waitcnt lgkmcnt(4)
    s_mov_b32 s64, 65536
    v_add_u32 v2, s64, v2
    v_add_u32 v3, s64, v3
    v_add_u32 v4, s64, v4
    v_add_u32 v5, s64, v5
    ds_read_b64_tr_b16 v[80:81], v2 offset:32768
    ds_read_b64_tr_b16 v[82:83], v2 offset:34816
    ds_read_b64_tr_b16 v[84:85], v3 offset:32768
    ds_read_b64_tr_b16 v[86:87], v3 offset:34816
    ds_read_b64_tr_b16 v[88:89], v4 offset:32768
    ds_read_b64_tr_b16 v[90:91], v4 offset:34816
    ds_read_b64_tr_b16 v[92:93], v5 offset:32768
    ds_read_b64_tr_b16 v[94:95], v5 offset:34816
    s_waitcnt vmcnt(6)
    v_mfma_f32_16x16x32_bf16 v[224:227], v[96:99], v[192:195], v[224:227]
    v_mfma_f32_16x16x32_bf16 v[228:231], v[96:99], v[196:199], v[228:231]
    v_mfma_f32_16x16x32_bf16 v[232:235], v[100:103], v[192:195], v[232:235]
    v_mfma_f32_16x16x32_bf16 v[236:239], v[100:103], v[196:199], v[236:239]
    v_mfma_f32_16x16x32_bf16 v[240:243], v[104:107], v[192:195], v[240:243]
    v_mfma_f32_16x16x32_bf16 v[244:247], v[104:107], v[196:199], v[244:247]
    v_mfma_f32_16x16x32_bf16 v[248:251], v[108:111], v[192:195], v[248:251]
    v_mfma_f32_16x16x32_bf16 v[252:255], v[108:111], v[196:199], v[252:255]
    s_add_u32 s65, s84, 8
    s_and_b32 s65, s65, 15
    s_lshr_b32 s66, s65, 2
    s_lshl_b32 s66, s66, 3
    s_lshl_b32 s65, s65, 11
L_p8:
    s_lshr_b32 s64, s79, s66
    s_and_b32 s64, s64, 0xff
    s_cbranch_scc1 L_go8
    s_sleep 4
    buffer_load_dword v28, v31, s[48:51], 0 offen sc1
    s_waitcnt vmcnt(0)
    v_readfirstlane_b32 s79, v28
    s_nop 1
    s_branch L_p8
L_go8:
    buffer_load_dwordx4 v[192:195], v6, s[80:83], s65 offen offset:0 sc1
    buffer_load_dwordx4 v[196:199], v6, s[80:83], s65 offen offset:1024 sc1
    s_waitcnt lgkmcnt(4)
    s_mov_b32 s64, 65536
    v_add_u32 v2, s64, v2
    v_add_u32 v3, s64, v3
    v_add_u32 v4, s64, v4
    v_add_u32 v5, s64, v5
    ds_read_b64_tr_b16 v[96:97], v2 offset:0
    ds_read_b64_tr_b16 v[98:99], v2 offset:2048
    ds_read_b64_tr_b16 v[100:101], v3 offset:0
    ds_read_b64_tr_b16 v[102:103], v3 offset:2048
    ds_read_b64_tr_b16 v[104:105], v4 offset:0
    ds_read_b64_tr_b16 v[106:107], v4 offset:2048
    ds_read_b64_tr_b16 v[108:109], v5 offset:0
    ds_read_b64_tr_b16 v[110:111], v5 offset:2048
    s_waitcnt vmcnt(6)
    v_mfma_f32_16x16x32_bf16 v[224:227], v[112:115], v[200:203], v[224:227]
    v_mfma_f32_16x16x32_bf16 v[228:231], v[112:115], v[204:207], v[228:231]
    v_mfma_f32_16x16x32_bf16 v[232:235], v[116:119], v[200:203], v[232:235]
    v_mfma_f32_16x16x32_bf16 v[236:239], v[116:119], v[204:207], v[236:239]
    v_mfma_f32_16x16x32_bf16 v[240:243], v[120:123], v[200:203], v[240:243]
    v_mfma_f32_16x16x32_bf16 v[244:247], v[120:123], v[204:207], v[244:247]
    v_mfma_f32_16x16x32_bf16 v[248:251], v[124:127], v[200:203], v[248:251]
    v_mfma_f32_16x16x32_bf16 v[252:255], v[124:127], v[204:207], v[252:255]
    buffer_load_dwordx4 v[200:203], v6, s[80:83], s65 offen offset:2048 sc1
    buffer_load_dwordx4 v[204:207], v6, s[80:83], s65 offen offset:3072 sc1
    s_waitcnt vmcnt(6)
    v_mfma_f32_16x16x32_bf16 v[224:227], v[128:131], v[208:211], v[224:227]
    v_mfma_f32_16x16x32_bf16 v[228:231], v[128:131], v[212:215], v[228:231]
    v_mfma_f32_16x16x32_bf16 v[232:235], v[132:135], v[208:211], v[232:235]
    v_mfma_f32_16x16x32_bf16 v[236:239], v[132:135], v[212:215], v[236:239]
    v_mfma_f32_16x16x32_bf16 v[240:243], v[136:139], v[208:211], v[240:243]
    v_mfma_f32_16x16x32_bf16 v[244:247], v[136:139], v[212:215], v[244:247]
    v_mfma_f32_16x16x32_bf16 v[248:251], v[140:143], v[208:211], v[248:251]
    v_mfma_f32_16x16x32_bf16 v[252:255], v[140:143], v[212:215], v[252:255]
    s_add_u32 s65, s84, 10
    s_and_b32 s65, s65, 15
    s_lshr_b32 s66, s65, 2
    s_lshl_b32 s66, s66, 3
    s_lshl_b32 s65, s65, 11
L_p10:
    s_lshr_b32 s64, s79, s66
    s_and_b32 s64, s64, 0xff
    s_cbranch_scc1 L_go10
    s_sleep 4
    buffer_load_dword v28, v31, s[48:51], 0 offen sc1
    s_waitcnt vmcnt(0)
    v_readfirstlane_b32 s79, v28
    s_nop 1
    s_branch L_p10
L_go10:
    buffer_load_dwordx4 v[208:211], v6, s[80:83], s65 offen offset:0 sc1
    buffer_load_dwordx4 v[212:215], v6, s[80:83], s65 offen offset:1024 sc1
    s_waitcnt vmcnt(6)
    v_mfma_f32_16x16x32_bf16 v[224:227], v[144:147], v[216:219], v[224:227]
    v_mfma_f32_16x16x32_bf16 v[228:231], v[144:147], v[220:223], v[228:231]
    v_mfma_f32_16x16x32_bf16 v[232:235], v[148:151], v[216:219], v[232:235]
    v_mfma_f32_16x16x32_bf16 v[236:239], v[148:151], v[220:223], v[236:239]
    v_mfma_f32_16x16x32_bf16 v[240:243], v[152:155], v[216:219], v[240:243]
    v_mfma_f32_16x16x32_bf16 v[244:247], v[152:155], v[220:223], v[244:247]
    v_mfma_f32_16x16x32_bf16 v[248:251], v[156:159], v[216:219], v[248:251]
    v_mfma_f32_16x16x32_bf16 v[252:255], v[156:159], v[220:223], v[252:255]
    buffer_load_dwordx4 v[216:219], v6, s[80:83], s65 offen offset:2048 sc1
    buffer_load_dwordx4 v[220:223], v6, s[80:83], s65 offen offset:3072 sc1
    s_waitcnt vmcnt(6)
    v_mfma_f32_16x16x32_bf16 v[224:227], v[160:163], v[192:195], v[224:227]
    v_mfma_f32_16x16x32_bf16 v[228:231], v[160:163], v[196:199], v[228:231]
    v_mfma_f32_16x16x32_bf16 v[232:235], v[164:167], v[192:195], v[232:235]
    v_mfma_f32_16x16x32_bf16 v[236:239], v[164:167], v[196:199], v[236:239]
    v_mfma_f32_16x16x32_bf16 v[240:243], v[168:171], v[192:195], v[240:243]
    v_mfma_f32_16x16x32_bf16 v[244:247], v[168:171], v[196:199], v[244:247]
    v_mfma_f32_16x16x32_bf16 v[248:251], v[172:175], v[192:195], v[248:251]
    v_mfma_f32_16x16x32_bf16 v[252:255], v[172:175], v[196:199], v[252:255]
    s_add_u32 s65, s84, 12
    s_and_b32 s65, s65, 15
    s_lshr_b32 s66, s65, 2
    s_lshl_b32 s66, s66, 3
    s_lshl_b32 s65, s65, 11
L_p12:
    s_lshr_b32 s64, s79, s66
    s_and_b32 s64, s64, 0xff
    s_cbranch_scc1 L_go12
    s_sleep 4
    buffer_load_dword v28, v31, s[48:51], 0 offen sc1
    s_waitcnt vmcnt(0)
    v_readfirstlane_b32 s79, v28
    s_nop 1
    s_branch L_p12
L_go12:
    buffer_load_dwordx4 v[192:195], v6, s[80:83], s65 offen offset:0 sc1
    buffer_load_dwordx4 v[196:199], v6, s[80:83], s65 offen offset:1024 sc1
    s_waitcnt vmcnt(6)
    v_mfma_f32_16x16x32_bf16 v[224:227], v[176:179], v[200:203], v[224:227]
    v_mfma_f32_16x16x32_bf16 v[228:231], v[176:179], v[204:207], v[228:231]
    v_mfma_f32_16x16x32_bf16 v[232:235], v[180:183], v[200:203], v[232:235]
    v_mfma_f32_16x16x32_bf16 v[236:239], v[180:183], v[204:207], v[236:239]
    v_mfma_f32_16x16x32_bf16 v[240:243], v[184:187], v[200:203], v[240:243]
    v_mfma_f32_16x16x32_bf16 v[244:247], v[184:187], v[204:207], v[244:247]
    v_mfma_f32_16x16x32_bf16 v[248:251], v[188:191], v[200:203], v[248:251]
    v_mfma_f32_16x16x32_bf16 v[252:255], v[188:191], v[204:207], v[252:255]
    buffer_load_dwordx4 v[200:203], v6, s[80:83], s65 offen offset:2048 sc1
    buffer_load_dwordx4 v[204:207], v6, s[80:83], s65 offen offset:3072 sc1
    s_waitcnt vmcnt(6)
    v_mfma_f32_16x16x32_bf16 v[224:227], v[8:11], v[208:211], v[224:227]
    v_mfma_f32_16x16x32_bf16 v[228:231], v[8:11], v[212:215], v[228:231]
    v_mfma_f32_16x16x32_bf16 v[232:235], v[12:15], v[208:211], v[232:235]
    v_mfma_f32_16x16x32_bf16 v[236:239], v[12:15], v[212:215], v[236:239]
    v_mfma_f32_16x16x32_bf16 v[240:243], v[16:19], v[208:211], v[240:243]
    v_mfma_f32_16x16x32_bf16 v[244:247], v[16:19], v[212:215], v[244:247]
    v_mfma_f32_16x16x32_bf16 v[248:251], v[20:23], v[208:211], v[248:251]
    v_mfma_f32_16x16x32_bf16 v[252:255], v[20:23], v[212:215], v[252:255]
    s_add_u32 s65, s84, 14
    s_and_b32 s65, s65, 15
    s_lshr_b32 s66, s65, 2
    s_lshl_b32 s66, s66, 3
    s_lshl_b32 s65, s65, 11
L_p14:
    s_lshr_b32 s64, s79, s66
    s_and_b32 s64, s64, 0xff
    s_cbranch_scc1 L_go14
    s_sleep 4
    buffer_load_dword v28, v31, s[48:51], 0 offen sc1
    s_waitcnt vmcnt(0)
    v_readfirstlane_b32 s79, v28
    s_nop 1
    s_branch L_p14
L_go14:
    buffer_load_dwordx4 v[208:211], v6, s[80:83], s65 offen offset:0 sc1
    buffer_load_dwordx4 v[212:215], v6, s[80:83], s65 offen offset:1024 sc1
    s_waitcnt vmcnt(6) lgkmcnt(0)
    v_mfma_f32_16x16x32_bf16 v[224:227], v[32:35], v[216:219], v[224:227]
    v_mfma_f32_16x16x32_bf16 v[228:231], v[32:35], v[220:223], v[228:231]
    v_mfma_f32_16x16x32_bf16 v[232:235], v[36:39], v[216:219], v[232:235]
    v_mfma_f32_16x16x32_bf16 v[236:239], v[36:39], v[220:223], v[236:239]
    v_mfma_f32_16x16x32_bf16 v[240:243], v[40:43], v[216:219], v[240:243]
    v_mfma_f32_16x16x32_bf16 v[244:247], v[40:43], v[220:223], v[244:247]
    v_mfma_f32_16x16x32_bf16 v[248:251], v[44:47], v[216:219], v[248:251]
    v_mfma_f32_16x16x32_bf16 v[252:255], v[44:47], v[220:223], v[252:255]
    buffer_load_dwordx4 v[216:219], v6, s[80:83], s65 offen offset:2048 sc1
    buffer_load_dwordx4 v[220:223], v6, s[80:83], s65 offen offset:3072 sc1
    s_waitcnt vmcnt(6)
    v_mfma_f32_16x16x32_bf16 v[224:227], v[48:51], v[192:195], v[224:227]
    v_mfma_f32_16x16x32_bf16 v[228:231], v[48:51], v[196:199], v[228:231]
    v_mfma_f32_16x16x32_bf16 v[232:235], v[52:55], v[192:195], v[232:235]
    v_mfma_f32_16x16x32_bf16 v[236:239], v[52:55], v[196:199], v[236:239]
    v_mfma_f32_16x16x32_bf16 v[240:243], v[56:59], v[192:195], v[240:243]
    v_mfma_f32_16x16x32_bf16 v[244:247], v[56:59], v[196:199], v[244:247]
    v_mfma_f32_16x16x32_bf16 v[248:251], v[60:63], v[192:195], v[248:251]
    v_mfma_f32_16x16x32_bf16 v[252:255], v[60:63], v[196:199], v[252:255]
    s_waitcnt vmcnt(4)
    v_mfma_f32_16x16x32_bf16 v[224:227], v[64:67], v[200:203], v[224:227]
    v_mfma_f32_16x16x32_bf16 v[228:231], v[64:67], v[204:207], v[228:231]
    v_mfma_f32_16x16x32_bf16 v[232:235], v[68:71], v[200:203], v[232:235]
    v_mfma_f32_16x16x32_bf16 v[236:239], v[68:71], v[204:207], v[236:239]
    v_mfma_f32_16x16x32_bf16 v[240:243], v[72:75], v[200:203], v[240:243]
    v_mfma_f32_16x16x32_bf16 v[244:247], v[72:75], v[204:207], v[244:247]
    v_mfma_f32_16x16x32_bf16 v[248:251], v[76:79], v[200:203], v[248:251]
    v_mfma_f32_16x16x32_bf16 v[252:255], v[76:79], v[204:207], v[252:255]
    s_waitcnt vmcnt(2)
    v_mfma_f32_16x16x32_bf16 v[224:227], v[80:83], v[208:211], v[224:227]
    v_mfma_f32_16x16x32_bf16 v[228:231], v[80:83], v[212:215], v[228:231]
    v_mfma_f32_16x16x32_bf16 v[232:235], v[84:87], v[208:211], v[232:235]
    v_mfma_f32_16x16x32_bf16 v[236:239], v[84:87], v[212:215], v[236:239]
    v_mfma_f32_16x16x32_bf16 v[240:243], v[88:91], v[208:211], v[240:243]
    v_mfma_f32_16x16x32_bf16 v[244:247], v[88:91], v[212:215], v[244:247]
    v_mfma_f32_16x16x32_bf16 v[248:251], v[92:95], v[208:211], v[248:251]
    v_mfma_f32_16x16x32_bf16 v[252:255], v[92:95], v[212:215], v[252:255]
    s_waitcnt vmcnt(0)
    v_mfma_f32_16x16x32_bf16 v[224:227], v[96:99], v[216:219], v[224:227]
    v_mfma_f32_16x16x32_bf16 v[228:231], v[96:99], v[220:223], v[228:231]
    v_mfma_f32_16x16x32_bf16 v[232:235], v[100:103], v[216:219], v[232:235]
    v_mfma_f32_16x16x32_bf16 v[236:239], v[100:103], v[220:223], v[236:239]
    v_mfma_f32_16x16x32_bf16 v[240:243], v[104:107], v[216:219], v[240:243]
    v_mfma_f32_16x16x32_bf16 v[244:247], v[104:107], v[220:223], v[244:247]
    v_mfma_f32_16x16x32_bf16 v[248:251], v[108:111], v[216:219], v[248:251]
    v_mfma_f32_16x16x32_bf16 v[252:255], v[108:111], v[220:223], v[252:255]
    s_barrier
    v_lshrrev_b32 v5, 4, v1
    v_and_b32 v2, 15, v1
    v_xor_b32 v3, v2, v5
    v_lshlrev_b32 v3, 4, v3
    v_lshl_add_u32 v3, v5, 9, v3
    s_lshl_b32 s64, s52, 13
    v_add_u32 v3, s64, v3
    s_nop 1
    v_xor_b32 v4, 0, v3
    ds_write_b128 v4, v[224:227] offset:0
    ds_write_b128 v4, v[228:231] offset:256
    v_xor_b32 v4, 64, v3
    ds_write_b128 v4, v[232:235] offset:2048
    ds_write_b128 v4, v[236:239] offset:2304
    v_xor_b32 v4, 128, v3
    ds_write_b128 v4, v[240:243] offset:4096
    ds_write_b128 v4, v[244:247] offset:4352
    v_xor_b32 v4, 192, v3
    ds_write_b128 v4, v[248:251] offset:6144
    ds_write_b128 v4, v[252:255] offset:6400
    s_lshl_b32 s64, s52, 2
    v_add_u32 v5, s64, v5
    v_xor_b32 v3, v5, v2
    v_lshlrev_b32 v3, 4, v3
    v_lshl_add_u32 v3, v2, 9, v3
    v_lshlrev_b32 v4, 3, v2
    v_lshl_add_u32 v4, v5, 10, v4
    s_waitcnt lgkmcnt(0)
    s_barrier
    ds_read_b128 v[192:195], v3 offset:0
    ds_read_b128 v[196:199], v3 offset:8192
    ds_read_b128 v[200:203], v3 offset:16384
    ds_read_b128 v[204:207], v3 offset:24576
    ds_read_b128 v[208:211], v3 offset:32768
    ds_read_b128 v[212:215], v3 offset:40960
    ds_read_b128 v[216:219], v3 offset:49152
    ds_read_b128 v[220:223], v3 offset:57344
    s_waitcnt lgkmcnt(6)
    v_add_f32 v192, v192, v196
    v_add_f32 v193, v193, v197
    v_add_f32 v194, v194, v198
    v_add_f32 v195, v195, v199
    s_waitcnt lgkmcnt(5)
    v_add_f32 v192, v192, v200
    v_add_f32 v193, v193, v201
    v_add_f32 v194, v194, v202
    v_add_f32 v195, v195, v203
    s_waitcnt lgkmcnt(4)
    v_add_f32 v192, v192, v204
    v_add_f32 v193, v193, v205
    v_add_f32 v194, v194, v206
    v_add_f32 v195, v195, v207
    s_waitcnt lgkmcnt(3)
    v_add_f32 v192, v192, v208
    v_add_f32 v193, v193, v209
    v_add_f32 v194, v194, v210
    v_add_f32 v195, v195, v211
    s_waitcnt lgkmcnt(2)
    v_add_f32 v192, v192, v212
    v_add_f32 v193, v193, v213
    v_add_f32 v194, v194, v214
    v_add_f32 v195, v195, v215
    s_waitcnt lgkmcnt(1)
    v_add_f32 v192, v192, v216
    v_add_f32 v193, v193, v217
    v_add_f32 v194, v194, v218
    v_add_f32 v195, v195, v219
    s_waitcnt lgkmcnt(0)
    v_add_f32 v192, v192, v220
    v_add_f32 v193, v193, v221
    v_add_f32 v194, v194, v222
    v_add_f32 v195, v195, v223
    v_cvt_pk_bf16_f32 v224, v192, v193
    v_cvt_pk_bf16_f32 v225, v194, v195
    buffer_store_dwordx2 v[224:225], v4, s[44:47], 0 offen
L_end:
    s_endpgm
.section .rodata,"a"
.p2align 6
.amdhsa_kernel standalone__mha_block_cached__near_ridge_kernel
  .amdhsa_next_free_vgpr 256
  .amdhsa_next_free_sgpr 96
  .amdhsa_accum_offset 256
  .amdhsa_group_segment_fixed_size 0
  .amdhsa_kernarg_size 64
  .amdhsa_user_sgpr_count 2
  .amdhsa_user_sgpr_kernarg_segment_ptr 1
  .amdhsa_system_sgpr_workgroup_id_x 1
.end_amdhsa_kernel
```
